```python
import torch

def _softmax(x, axis=-1):
    return torch.softmax(x, dim=axis)
def _gelu(x):
    return torch.nn.functional.gelu(x, approximate="tanh")
def _silu(x):
    return torch.nn.functional.silu(x)
def _sigmoid(x):
    return torch.sigmoid(x)
def _layernorm(x, axis=-1, eps=1e-5):
    m = x.mean(dim=axis, keepdim=True)
    v = x.var(dim=axis, keepdim=True, unbiased=False)
    return (x - m) / torch.sqrt(v + eps)
def _scatter_add(tgt, idx, src, axis=0):
    return tgt.clone().index_add_(axis, idx, src)
def _segment_sum(src, seg, n):
    out = torch.zeros((n,) + src.shape[1:], dtype=src.dtype)
    return out.index_add_(0, seg, src)
def _pad(x, pw):
    flat = tuple(v for pair in reversed(pw) for v in pair)
    return torch.nn.functional.pad(x, flat)

kernel_name = 'concat_heads__ssm_conv_h3__ssm_conv_s4__prompt'

def setup_inputs():

    _w = (lambda a: (lambda t: t.to(torch.bfloat16) if t.is_floating_point() else t)(torch.as_tensor(a)))
    def _A_setup():
        B, S, D = 1, 2048, 640
        ks = 4
        return {
            "q": _w((lambda *s: torch.randn(*s, dtype=torch.bfloat16) * 0.05)(B, S, D)),
            "k": _w((lambda *s: torch.randn(*s, dtype=torch.bfloat16) * 0.2)(B, S, D)),
            "v": _w((lambda *s: torch.randn(*s, dtype=torch.bfloat16) * 0.2)(B, S, D)),
            "shift_k": _w((lambda *s: torch.randn(*s, dtype=torch.bfloat16) * 0.2)(D, ks) * 0.5),
            "ssm_k": _w((lambda *s: torch.randn(*s, dtype=torch.bfloat16) * 0.8)(D, S) * (1.0 / S ** 0.5)),
            "ssm_D": _w((lambda *s: torch.randn(*s, dtype=torch.bfloat16) * 0.2)(D)),
        }
    _A_in = _A_setup()

    def _B_setup():
        B, L, D, N = 1, 2048, 640, 128
        A_re = -(lambda _x: torch.exp(torch.as_tensor(_x)))((lambda *s: torch.randn(*s, dtype=torch.bfloat16) * 3.2)(D, N))
        A_im = torch.pi * (lambda *s: torch.randn(*s, dtype=torch.bfloat16) * 0.05)(D, N)
        B_re = (lambda *s: torch.randn(*s, dtype=torch.bfloat16) * 0.1)(D, N)
        B_im = (lambda *s: torch.randn(*s, dtype=torch.bfloat16) * 0.1)(D, N)
        C_re = (lambda *s: torch.randn(*s, dtype=torch.bfloat16) * 0.1)(D, N)
        C_im = (lambda *s: torch.randn(*s, dtype=torch.bfloat16) * 0.1)(D, N)
        log_dt = (lambda *s: torch.randn(*s, dtype=torch.bfloat16) * 0.05)(D) * 0.5 - 4.0
        Dskip = (lambda *s: torch.randn(*s, dtype=torch.bfloat16) * 0.05)(D)
        return {
            "u": _w((lambda *s: torch.randn(*s, dtype=torch.bfloat16) * 0.05)(B, L, D)),
            "A_re": _w(A_re),
            "A_im": _w(A_im),
            "B_re": _w(B_re),
            "B_im": _w(B_im),
            "C_re": _w(C_re),
            "C_im": _w(C_im),
            "log_dt": _w(log_dt),
            "Dskip": _w(Dskip),
        }
    _B_in = _B_setup()

    return {
        "A_q": _A_in["q"],
        "A_k": _A_in["k"],
        "A_v": _A_in["v"],
        "A_shift_k": _A_in["shift_k"],
        "A_ssm_k": _A_in["ssm_k"],
        "A_ssm_D": _A_in["ssm_D"],
        "B_u": _B_in["u"],
        "B_A_re": _B_in["A_re"],
        "B_A_im": _B_in["A_im"],
        "B_B_re": _B_in["B_re"],
        "B_B_im": _B_in["B_im"],
        "B_C_re": _B_in["C_re"],
        "B_C_im": _B_in["C_im"],
        "B_log_dt": _B_in["log_dt"],
        "B_Dskip": _B_in["Dskip"],
    }

def reference(A_q, A_k, A_v, A_shift_k, A_ssm_k, A_ssm_D, B_u, B_A_re, B_A_im, B_B_re, B_B_im, B_C_re, B_C_im, B_log_dt, B_Dskip):
    def _A_ref(q, k, v, shift_k, ssm_k, ssm_D):
        B, S, D = q.shape
        ks = shift_k.shape[-1]
        k_pad = _pad(k, ((0, 0), (ks - 1, 0), (0, 0)))
        k_shift = torch.zeros_like(k)
        for t in range(ks):
            k_shift = k_shift + k_pad[:, t:t + S, :] * shift_k[:, ks - 1 - t][None, None, :]
        kv = k_shift * v
        L = 2 * S
        kv_pad = _pad(kv, ((0, 0), (0, S), (0, 0)))
        kf_pad = _pad(ssm_k, ((0, 0), (0, S)))
        kv_f = (lambda x, axes=(-2,-1): torch.fft.rfft2(x.float(), dim=axes))(kv_pad[:, None, :, :], axes=(1, 2))
        kf_f = (lambda x, axes=(-2,-1): torch.fft.rfft2(x.float(), dim=axes))(kf_pad[:, None, :], axes=(1, 2))
        kf_f = (lambda x, *d: x.permute(*d))(kf_f, 1, 2, 0)
        y_f = kv_f * kf_f[None, :, :, :]
        y = (lambda x, s, axes=(-2,-1): torch.fft.irfft2(x, s=s, dim=axes).to(torch.bfloat16))(y_f, (1, L), axes=(1, 2))[:, 0, :S, :]
        y = y + kv * ssm_D[None, None, :]
        return q * y

    def _B_ref(u, A_re, A_im, B_re, B_im, C_re, C_im, log_dt, Dskip):
        Bsz, L, D = u.shape
        dt = torch.exp(log_dt)[:, None]
        A = A_re + 1j * A_im
        Bc = B_re + 1j * B_im
        Cc = C_re + 1j * C_im
        logdA = dt * A
        dB = dt * Bc
        l = (lambda x, dt: x.to(dt))(torch.arange(L), A_re.dtype)
        P = torch.exp(logdA[:, :, None] * l[None, None, :])
        K = torch.einsum("dn,dnl,dn->dl", Cc, P, dB).real
        L2 = 2 * L
        Kp = _pad(K, ((0, 0), (0, L)))
        up = (lambda x, *d: x.permute(*d))(u, 0, 2, 1)
        up = _pad(up, ((0, 0), (0, 0), (0, L)))
        Kf = (lambda x, axes=(-2,-1): torch.fft.rfft2(x.float(), dim=axes))(Kp[:, None, :], axes=(-2, -1))
        Uf = (lambda x, axes=(-2,-1): torch.fft.rfft2(x.float(), dim=axes))(up[:, :, None, :], axes=(-2, -1))
        Yf = Uf * Kf[None, :, :, :]
        y = (lambda x, s, axes=(-2,-1): torch.fft.irfft2(x, s=s, dim=axes).to(torch.bfloat16))(Yf, (1, L2), axes=(-2, -1))[:, :, 0, :L]
        y = (lambda x, *d: x.permute(*d))(y, 0, 2, 1) + u * Dskip[None, None, :]
        return y

    a = _A_ref(A_q, A_k, A_v, A_shift_k, A_ssm_k, A_ssm_D)
    b = _B_ref(B_u, B_A_re, B_A_im, B_B_re, B_B_im, B_C_re, B_C_im, B_log_dt, B_Dskip)
    return torch.concatenate([a, b], axis=-1)
```

```asm
; @launch grid=(256,1,1) block=(768,1,1) lds=163840
.amdgcn_target "amdgcn-amd-amdhsa--gfx950"
.text
.globl concat_heads__ssm_conv_h3__ssm_conv_s4__prompt_kernel
.p2align 8
.type concat_heads__ssm_conv_h3__ssm_conv_s4__prompt_kernel,@function
concat_heads__ssm_conv_h3__ssm_conv_s4__prompt_kernel:
    s_cmp_ge_u32 s2, 256
    s_cbranch_scc1 L_end
    s_load_dwordx16 s[4:19], s[0:1], 0
    s_load_dwordx16 s[20:35], s[0:1], 64
    s_and_b32 s99, s2, 7
    s_lshr_b32 s100, s2, 3
    s_and_b32 s42, s100, 7
    s_lshr_b32 s100, s100, 3
    s_and_b32 s3, s99, 3
    s_lshl_b32 s3, s3, 3
    s_mov_b32 s41, 0x5040200
    s_mov_b32 s101, 0x9080706
    s_cmp_eq_u32 s100, 1
    s_cselect_b32 s41, 0x24220301, s41
    s_cselect_b32 s101, 0x2c2a2826, s101
    s_cmp_eq_u32 s100, 2
    s_cselect_b32 s41, 0x25232120, s41
    s_cselect_b32 s101, 0x2d2b2927, s101
    s_cmp_eq_u32 s100, 3
    s_cselect_b32 s41, 0x31304040, s41
    s_cselect_b32 s101, 0x2f2e3332, s101
    s_cmp_ge_u32 s99, 4
    s_cselect_b32 s41, s101, s41
    s_lshr_b32 s41, s41, s3
    s_and_b32 s41, s41, 0xff
    s_mov_b32 s97, 0x0
    s_mov_b32 s101, 0x0
    s_cmp_eq_u32 s100, 1
    s_cselect_b32 s97, 0x29210000, s97
    s_cselect_b32 s101, 0x49413931, s101
    s_cmp_eq_u32 s100, 2
    s_cselect_b32 s97, 0x2a221101, s97
    s_cselect_b32 s101, 0x4a423a32, s101
    s_cmp_eq_u32 s100, 3
    s_cselect_b32 s97, 0x2c241f0f, s97
    s_cselect_b32 s101, 0x4c443c34, s101
    s_cmp_ge_u32 s99, 4
    s_cselect_b32 s97, s101, s97
    s_lshr_b32 s97, s97, s3
    s_and_b32 s97, s97, 0xff
    s_lshr_b32 s3, s41, 5
    s_and_b32 s41, s41, 31
    s_lshl_b32 s43, s41, 3
    s_add_u32 s43, s43, s42
    s_cmp_eq_u32 s3, 1
    s_cselect_b32 s99, 2, 3
    s_lshl_b32 s43, s43, s99
    s_cmp_lg_u32 s42, 0
    s_cbranch_scc1 L_pcs
    s_getpc_b64 s[36:37]
L_pc:
    v_lshlrev_b32 v33, 7, v0
    v_mov_b32 v37, s37
    v_min_u32 v33, L_end-L_pc, v33
    v_add_co_u32 v36, vcc, s36, v33
    s_nop 1
    v_addc_co_u32 v37, vcc, 0, v37, vcc
    v_cmp_gt_u32 vcc, 256, v0
    s_and_saveexec_b64 s[38:39], vcc
    s_cbranch_execz L_pcd
    global_load_dword v38, v[36:37], off
L_pcd:
    s_mov_b64 exec, s[38:39]
L_pcs:
    v_lshrrev_b32 v32, 6, v0
    v_and_b32 v1, 63, v0
    s_mov_b32 s96, 0x3f803f80
    v_readfirstlane_b32 s40, v32
    s_nop 3
    s_cmp_eq_u32 s3, 0
    s_cbranch_scc0 L_nA
    s_cmp_ge_u32 s40, 8
    s_cbranch_scc1 L_servA
    s_branch L_addr
L_nA:
    s_cmp_ge_u32 s40, 8
    s_cbranch_scc1 L_end
    s_cmp_ge_u32 s40, 4
    s_cbranch_scc1 L_helper
    s_cmp_lg_u32 s3, 2
    s_cbranch_scc1 L_addr
    s_sub_u32 s97, s97, 9
    s_add_u32 s40, s40, 4
    v_add_u32 v0, 256, v0
    s_branch L_helper
L_addr:
    v_and_b32 v32, 15, v1
    v_lshrrev_b32 v33, 4, v1
    v_add_u32 v34, 1, v32
    v_and_b32 v35, 3, v34
    v_sub_u32 v34, v34, v35
    v_lshlrev_b32 v34, 1, v34
    v_mul_u32_u24 v35, 4160, v35
    v_add_u32 v34, v34, v35
    v_lshl_add_u32 v34, v33, 4, v34
    s_mul_i32 s100, s40, 16896
    v_add_u32 v2, s100, v34
    s_mul_i32 s99, s40, 3584
    s_add_u32 s99, s99, 135168
    v_lshlrev_b32 v34, 5, v32
    v_lshl_add_u32 v35, v33, 3, v34
    v_add_u32 v4, s99, v35
    s_add_u32 s100, s100, 3136
    v_add_u32 v5, s100, v35
    v_lshlrev_b32 v35, 4, v33
    v_sub_u32 v35, v35, v34
    s_add_u32 s99, s99, 480
    v_add_u32 v3, s99, v35
    s_waitcnt lgkmcnt(0)
    s_cmp_eq_u32 s3, 1
    s_cbranch_scc1 L_pathB
    s_add_u32 s99, s43, s40
    s_lshl_b32 s99, s99, 12
    s_add_u32 s56, s12, s99
    s_addc_u32 s57, s13, 0
    s_and_b32 s57, s57, 0xffff
    s_mov_b32 s58, 4096
    s_mov_b32 s59, 0x00020000
    v_lshlrev_b32 v32, 4, v1
    buffer_load_dwordx4 v[40:43], v32, s[56:59], 0 offen offset:0
    buffer_load_dwordx2 v[44:45], v32, s[56:59], 0 offen offset:16
    buffer_load_dwordx4 v[48:51], v32, s[56:59], 0 offen offset:1024
    buffer_load_dwordx2 v[52:53], v32, s[56:59], 0 offen offset:1040
    s_mul_i32 s99, s40, 16896
    v_lshl_add_u32 v37, v1, 4, s99
    s_waitcnt vmcnt(0)
    buffer_load_dwordx4 v[56:59], v32, s[56:59], 0 offen offset:2048
    buffer_load_dwordx2 v[60:61], v32, s[56:59], 0 offen offset:2064
    buffer_load_dwordx4 v[64:67], v32, s[56:59], 0 offen offset:3072
    buffer_load_dwordx2 v[68:69], v32, s[56:59], 0 offen offset:3088
    v_mov_b32 v104, 0
    v_mov_b32 v105, 0
    v_mov_b32 v106, 0
    v_mov_b32 v107, 0
    v_lshlrev_b32 v108, 16, v40
    v_alignbit_b32 v109, v41, v40, 16
    s_mov_b64 s[20:21], exec
    s_mov_b64 exec, 3
    ds_write_b128 v37, v[104:107] offset:0
    ds_write_b128 v37, v[104:107] offset:4160
    ds_write_b128 v37, v[104:107] offset:8320
    ds_write_b128 v37, v[104:107] offset:12480
    s_mov_b64 exec, 1
    ds_write_b32 v37, v108 offset:4188
    ds_write_b32 v37, v40 offset:8348
    ds_write_b64 v37, v[108:109] offset:12504
    s_mov_b64 exec, s[20:21]
    ds_write_b128 v37, v[40:43] offset:32
    v_alignbit_b32 v112, v41, v40, 16
    v_alignbit_b32 v113, v42, v41, 16
    v_alignbit_b32 v114, v43, v42, 16
    v_alignbit_b32 v115, v44, v43, 16
    ds_write_b128 v37, v[112:115] offset:4192
    v_mov_b32 v120, v41
    v_mov_b32 v121, v42
    v_mov_b32 v122, v43
    v_mov_b32 v123, v44
    ds_write_b128 v37, v[120:123] offset:8352
    v_alignbit_b32 v116, v42, v41, 16
    v_alignbit_b32 v117, v43, v42, 16
    v_alignbit_b32 v118, v44, v43, 16
    v_alignbit_b32 v119, v45, v44, 16
    ds_write_b128 v37, v[116:119] offset:12512
    ds_write_b128 v37, v[48:51] offset:1056
    v_alignbit_b32 v124, v49, v48, 16
    v_alignbit_b32 v125, v50, v49, 16
    v_alignbit_b32 v126, v51, v50, 16
    v_alignbit_b32 v127, v52, v51, 16
    ds_write_b128 v37, v[124:127] offset:5216
    v_mov_b32 v132, v49
    v_mov_b32 v133, v50
    v_mov_b32 v134, v51
    v_mov_b32 v135, v52
    ds_write_b128 v37, v[132:135] offset:9376
    v_alignbit_b32 v128, v50, v49, 16
    v_alignbit_b32 v129, v51, v50, 16
    v_alignbit_b32 v130, v52, v51, 16
    v_alignbit_b32 v131, v53, v52, 16
    ds_write_b128 v37, v[128:131] offset:13536
    s_waitcnt vmcnt(0)
    ds_write_b128 v37, v[56:59] offset:2080
    v_alignbit_b32 v112, v57, v56, 16
    v_alignbit_b32 v113, v58, v57, 16
    v_alignbit_b32 v114, v59, v58, 16
    v_alignbit_b32 v115, v60, v59, 16
    ds_write_b128 v37, v[112:115] offset:6240
    v_mov_b32 v120, v57
    v_mov_b32 v121, v58
    v_mov_b32 v122, v59
    v_mov_b32 v123, v60
    ds_write_b128 v37, v[120:123] offset:10400
    v_alignbit_b32 v116, v58, v57, 16
    v_alignbit_b32 v117, v59, v58, 16
    v_alignbit_b32 v118, v60, v59, 16
    v_alignbit_b32 v119, v61, v60, 16
    ds_write_b128 v37, v[116:119] offset:14560
    ds_write_b128 v37, v[64:67] offset:3104
    v_alignbit_b32 v124, v65, v64, 16
    v_alignbit_b32 v125, v66, v65, 16
    v_alignbit_b32 v126, v67, v66, 16
    v_alignbit_b32 v127, v68, v67, 16
    ds_write_b128 v37, v[124:127] offset:7264
    v_mov_b32 v132, v65
    v_mov_b32 v133, v66
    v_mov_b32 v134, v67
    v_mov_b32 v135, v68
    ds_write_b128 v37, v[132:135] offset:11424
    v_alignbit_b32 v128, v66, v65, 16
    v_alignbit_b32 v129, v67, v66, 16
    v_alignbit_b32 v130, v68, v67, 16
    v_alignbit_b32 v131, v69, v68, 16
    ds_write_b128 v37, v[128:131] offset:15584
    s_branch L_conv
L_pathB:
    s_add_u32 s99, s43, s40
    s_lshl_b32 s100, s99, 8
    v_lshl_add_u32 v32, v1, 2, s100
    global_load_dword v80, v32, s[18:19]
    global_load_dword v81, v32, s[20:21]
    global_load_dword v82, v32, s[22:23]
    global_load_dword v83, v32, s[24:25]
    global_load_dword v84, v32, s[26:27]
    global_load_dword v85, v32, s[28:29]
    s_barrier
    s_lshl_b32 s100, s99, 1
    s_and_b32 s100, s100, -4
    s_add_u32 s64, s30, s100
    s_addc_u32 s65, s31, 0
    s_load_dword s66, s[64:65], 0
    s_and_b32 s68, s99, 1
    s_waitcnt lgkmcnt(0)
    s_lshl_b32 s67, s66, 16
    s_and_b32 s66, s66, 0xffff0000
    s_cmp_eq_u32 s68, 1
    s_cselect_b32 s66, s66, s67
    v_mov_b32 v86, 0x3fb8aa3b
    v_mul_f32 v86, s66, v86
    v_exp_f32 v86, v86
    s_mul_i32 s99, s40, 16896
    v_cvt_pk_bf16_f32 v86, 0, v86
    v_lshl_add_u32 v33, v1, 3, s99
    v_and_b32 v34, 15, v1
    v_mul_u32_u24 v34, 528, v34
    v_lshrrev_b32 v35, 4, v1
    v_lshl_add_u32 v34, v35, 4, v34
    v_add_u32 v34, s99, v34
    s_waitcnt vmcnt(0)
    v_lshlrev_b32 v72, 16, v80
    v_lshlrev_b32 v73, 16, v81
    v_lshlrev_b32 v112, 16, v82
    v_lshlrev_b32 v113, 16, v83
    v_lshlrev_b32 v114, 16, v84
    v_lshlrev_b32 v115, 16, v85
    v_and_b32 v118, 0xffff0000, v80
    v_and_b32 v119, 0xffff0000, v81
    v_and_b32 v158, 0xffff0000, v82
    v_and_b32 v159, 0xffff0000, v83
    v_and_b32 v160, 0xffff0000, v84
    v_and_b32 v161, 0xffff0000, v85
    v_mul_f32 v72, v86, v72
    v_mul_f32 v73, v86, v73
    v_mul_f32 v72, 0x3fb8aa3b, v72
    v_mul_f32 v73, 0.15915494, v73
    v_mul_f32 v112, v86, v112
    v_mul_f32 v113, v86, v113
    v_pk_mul_f32 v[74:75], v[114:115], v[112:113] op_sel_hi:[1,0]
    v_pk_fma_f32 v[74:75], v[114:115], v[112:113], v[74:75] op_sel:[1,1,0] op_sel_hi:[0,1,1] neg_lo:[1,0,0]
    v_mul_f32 v118, v86, v118
    v_mul_f32 v119, v86, v119
    v_mul_f32 v118, 0x3fb8aa3b, v118
    v_mul_f32 v119, 0.15915494, v119
    v_mul_f32 v158, v86, v158
    v_mul_f32 v159, v86, v159
    v_pk_mul_f32 v[120:121], v[160:161], v[158:159] op_sel_hi:[1,0]
    v_pk_fma_f32 v[120:121], v[160:161], v[158:159], v[120:121] op_sel:[1,1,0] op_sel_hi:[0,1,1] neg_lo:[1,0,0]
    v_max_f32 v24, |v74|, |v75|
    v_max3_f32 v24, |v120|, |v121|, v24
    v_mul_f32 v112, 1.0, v72
    v_mul_f32 v113, 1.0, v73
    v_max_f32_dpp v24, v24, v24 row_shr:1 row_mask:0xf bank_mask:0xf
    v_exp_f32 v112, v112
    v_fract_f32 v113, v113
    v_cos_f32 v114, v113
    v_sin_f32 v115, v113
    s_nop 0
    v_mul_f32 v76, v112, v114
    v_mul_f32 v77, v112, v115
    v_mul_f32 v158, 1.0, v118
    v_mul_f32 v159, 1.0, v119
    v_max_f32_dpp v24, v24, v24 row_shr:2 row_mask:0xf bank_mask:0xf
    v_exp_f32 v158, v158
    v_fract_f32 v159, v159
    v_cos_f32 v160, v159
    v_sin_f32 v161, v159
    s_nop 0
    v_mul_f32 v122, v158, v160
    v_mul_f32 v123, v158, v161
    v_mul_f32 v112, 0x41000000, v72
    v_mul_f32 v113, 0x41000000, v73
    v_max_f32_dpp v24, v24, v24 row_shr:4 row_mask:0xf bank_mask:0xf
    v_exp_f32 v112, v112
    v_fract_f32 v113, v113
    v_cos_f32 v114, v113
    v_sin_f32 v115, v113
    s_nop 0
    v_mul_f32 v90, v112, v114
    v_mul_f32 v91, v112, v115
    v_mul_f32 v158, 0x41000000, v118
    v_mul_f32 v159, 0x41000000, v119
    v_max_f32_dpp v24, v24, v24 row_shr:8 row_mask:0xf bank_mask:0xf
    v_exp_f32 v158, v158
    v_fract_f32 v159, v159
    v_cos_f32 v160, v159
    v_sin_f32 v161, v159
    s_nop 0
    v_mul_f32 v136, v158, v160
    v_mul_f32 v137, v158, v161
    v_mul_f32 v112, 0x43000000, v72
    v_mul_f32 v113, 0x43000000, v73
    v_max_f32_dpp v24, v24, v24 row_bcast:15 row_mask:0xa bank_mask:0xf
    v_exp_f32 v112, v112
    v_fract_f32 v113, v113
    v_cos_f32 v114, v113
    v_sin_f32 v115, v113
    s_nop 0
    v_mul_f32 v106, v112, v114
    v_mul_f32 v107, v112, v115
    v_mul_f32 v158, 0x43000000, v118
    v_mul_f32 v159, 0x43000000, v119
    v_max_f32_dpp v24, v24, v24 row_bcast:31 row_mask:0xc bank_mask:0xf
    v_exp_f32 v158, v158
    v_fract_f32 v159, v159
    v_cos_f32 v160, v159
    v_sin_f32 v161, v159
    s_nop 0
    v_mul_f32 v152, v158, v160
    v_mul_f32 v153, v158, v161
    v_readlane_b32 s22, v24, 63
    v_mov_b32 v30, 0x3c00
    v_mov_b32 v31, 0x3c00
    ds_write_b64 v33, v[30:31] offset:0
    s_and_b32 s22, s22, 0x7f800000
    s_sub_u32 s99, 0x7f000000, s22
    v_mul_f32 v74, s99, v74
    v_mul_f32 v75, s99, v75
    v_mul_f32 v120, s99, v120
    v_mul_f32 v121, s99, v121
    v_cvt_pk_f16_f32 v24, v90, -v91
    v_cvt_pk_f16_f32 v25, v136, -v137
    ds_write_b64 v33, v[24:25] offset:528
    v_pk_mul_f32 v[92:93], v[90:91], v[90:91] op_sel_hi:[1,0]
    v_pk_fma_f32 v[92:93], v[90:91], v[90:91], v[92:93] op_sel:[1,1,0] op_sel_hi:[0,1,1] neg_lo:[1,0,0]
    v_pk_mul_f32 v[138:139], v[136:137], v[136:137] op_sel_hi:[1,0]
    v_pk_fma_f32 v[138:139], v[136:137], v[136:137], v[138:139] op_sel:[1,1,0] op_sel_hi:[0,1,1] neg_lo:[1,0,0]
    v_cvt_pk_f16_f32 v26, v92, -v93
    v_cvt_pk_f16_f32 v27, v138, -v139
    ds_write_b64 v33, v[26:27] offset:1056
    v_pk_mul_f32 v[94:95], v[90:91], v[92:93] op_sel_hi:[1,0]
    v_pk_fma_f32 v[94:95], v[90:91], v[92:93], v[94:95] op_sel:[1,1,0] op_sel_hi:[0,1,1] neg_lo:[1,0,0]
    v_pk_mul_f32 v[140:141], v[136:137], v[138:139] op_sel_hi:[1,0]
    v_pk_fma_f32 v[140:141], v[136:137], v[138:139], v[140:141] op_sel:[1,1,0] op_sel_hi:[0,1,1] neg_lo:[1,0,0]
    v_cvt_pk_f16_f32 v28, v94, -v95
    v_cvt_pk_f16_f32 v29, v140, -v141
    ds_write_b64 v33, v[28:29] offset:1584
    v_pk_mul_f32 v[96:97], v[92:93], v[92:93] op_sel_hi:[1,0]
    v_pk_fma_f32 v[96:97], v[92:93], v[92:93], v[96:97] op_sel:[1,1,0] op_sel_hi:[0,1,1] neg_lo:[1,0,0]
    v_pk_mul_f32 v[142:143], v[138:139], v[138:139] op_sel_hi:[1,0]
    v_pk_fma_f32 v[142:143], v[138:139], v[138:139], v[142:143] op_sel:[1,1,0] op_sel_hi:[0,1,1] neg_lo:[1,0,0]
    v_cvt_pk_f16_f32 v30, v96, -v97
    v_cvt_pk_f16_f32 v31, v142, -v143
    ds_write_b64 v33, v[30:31] offset:2112
    v_pk_mul_f32 v[98:99], v[92:93], v[94:95] op_sel_hi:[1,0]
    v_pk_fma_f32 v[98:99], v[92:93], v[94:95], v[98:99] op_sel:[1,1,0] op_sel_hi:[0,1,1] neg_lo:[1,0,0]
    v_pk_mul_f32 v[144:145], v[138:139], v[140:141] op_sel_hi:[1,0]
    v_pk_fma_f32 v[144:145], v[138:139], v[140:141], v[144:145] op_sel:[1,1,0] op_sel_hi:[0,1,1] neg_lo:[1,0,0]
    v_cvt_pk_f16_f32 v24, v98, -v99
    v_cvt_pk_f16_f32 v25, v144, -v145
    ds_write_b64 v33, v[24:25] offset:2640
    v_pk_mul_f32 v[100:101], v[94:95], v[94:95] op_sel_hi:[1,0]
    v_pk_fma_f32 v[100:101], v[94:95], v[94:95], v[100:101] op_sel:[1,1,0] op_sel_hi:[0,1,1] neg_lo:[1,0,0]
    v_pk_mul_f32 v[146:147], v[140:141], v[140:141] op_sel_hi:[1,0]
    v_pk_fma_f32 v[146:147], v[140:141], v[140:141], v[146:147] op_sel:[1,1,0] op_sel_hi:[0,1,1] neg_lo:[1,0,0]
    v_cvt_pk_f16_f32 v26, v100, -v101
    v_cvt_pk_f16_f32 v27, v146, -v147
    ds_write_b64 v33, v[26:27] offset:3168
    v_pk_mul_f32 v[102:103], v[94:95], v[96:97] op_sel_hi:[1,0]
    v_pk_fma_f32 v[102:103], v[94:95], v[96:97], v[102:103] op_sel:[1,1,0] op_sel_hi:[0,1,1] neg_lo:[1,0,0]
    v_pk_mul_f32 v[148:149], v[140:141], v[142:143] op_sel_hi:[1,0]
    v_pk_fma_f32 v[148:149], v[140:141], v[142:143], v[148:149] op_sel:[1,1,0] op_sel_hi:[0,1,1] neg_lo:[1,0,0]
    v_cvt_pk_f16_f32 v28, v102, -v103
    v_cvt_pk_f16_f32 v29, v148, -v149
    ds_write_b64 v33, v[28:29] offset:3696
    v_pk_mul_f32 v[104:105], v[96:97], v[96:97] op_sel_hi:[1,0]
    v_pk_fma_f32 v[104:105], v[96:97], v[96:97], v[104:105] op_sel:[1,1,0] op_sel_hi:[0,1,1] neg_lo:[1,0,0]
    v_pk_mul_f32 v[150:151], v[142:143], v[142:143] op_sel_hi:[1,0]
    v_pk_fma_f32 v[150:151], v[142:143], v[142:143], v[150:151] op_sel:[1,1,0] op_sel_hi:[0,1,1] neg_lo:[1,0,0]
    v_cvt_pk_f16_f32 v30, v104, -v105
    v_cvt_pk_f16_f32 v31, v150, -v151
    ds_write_b64 v33, v[30:31] offset:4224
    v_pk_mul_f32 v[112:113], v[104:105], v[90:91] op_sel_hi:[1,0]
    v_pk_fma_f32 v[112:113], v[104:105], v[90:91], v[112:113] op_sel:[1,1,0] op_sel_hi:[0,1,1] neg_lo:[1,0,0]
    v_pk_mul_f32 v[158:159], v[150:151], v[136:137] op_sel_hi:[1,0]
    v_pk_fma_f32 v[158:159], v[150:151], v[136:137], v[158:159] op_sel:[1,1,0] op_sel_hi:[0,1,1] neg_lo:[1,0,0]
    v_cvt_pk_f16_f32 v24, v112, -v113
    v_cvt_pk_f16_f32 v25, v158, -v159
    ds_write_b64 v33, v[24:25] offset:4752
    v_pk_mul_f32 v[114:115], v[104:105], v[92:93] op_sel_hi:[1,0]
    v_pk_fma_f32 v[114:115], v[104:105], v[92:93], v[114:115] op_sel:[1,1,0] op_sel_hi:[0,1,1] neg_lo:[1,0,0]
    v_pk_mul_f32 v[160:161], v[150:151], v[138:139] op_sel_hi:[1,0]
    v_pk_fma_f32 v[160:161], v[150:151], v[138:139], v[160:161] op_sel:[1,1,0] op_sel_hi:[0,1,1] neg_lo:[1,0,0]
    v_cvt_pk_f16_f32 v26, v114, -v115
    v_cvt_pk_f16_f32 v27, v160, -v161
    ds_write_b64 v33, v[26:27] offset:5280
    v_pk_mul_f32 v[116:117], v[104:105], v[94:95] op_sel_hi:[1,0]
    v_pk_fma_f32 v[116:117], v[104:105], v[94:95], v[116:117] op_sel:[1,1,0] op_sel_hi:[0,1,1] neg_lo:[1,0,0]
    v_pk_mul_f32 v[162:163], v[150:151], v[140:141] op_sel_hi:[1,0]
    v_pk_fma_f32 v[162:163], v[150:151], v[140:141], v[162:163] op_sel:[1,1,0] op_sel_hi:[0,1,1] neg_lo:[1,0,0]
    v_cvt_pk_f16_f32 v28, v116, -v117
    v_cvt_pk_f16_f32 v29, v162, -v163
    ds_write_b64 v33, v[28:29] offset:5808
    v_pk_mul_f32 v[112:113], v[104:105], v[96:97] op_sel_hi:[1,0]
    v_pk_fma_f32 v[112:113], v[104:105], v[96:97], v[112:113] op_sel:[1,1,0] op_sel_hi:[0,1,1] neg_lo:[1,0,0]
    v_pk_mul_f32 v[158:159], v[150:151], v[142:143] op_sel_hi:[1,0]
    v_pk_fma_f32 v[158:159], v[150:151], v[142:143], v[158:159] op_sel:[1,1,0] op_sel_hi:[0,1,1] neg_lo:[1,0,0]
    v_cvt_pk_f16_f32 v30, v112, -v113
    v_cvt_pk_f16_f32 v31, v158, -v159
    ds_write_b64 v33, v[30:31] offset:6336
    v_pk_mul_f32 v[114:115], v[104:105], v[98:99] op_sel_hi:[1,0]
    v_pk_fma_f32 v[114:115], v[104:105], v[98:99], v[114:115] op_sel:[1,1,0] op_sel_hi:[0,1,1] neg_lo:[1,0,0]
    v_pk_mul_f32 v[160:161], v[150:151], v[144:145] op_sel_hi:[1,0]
    v_pk_fma_f32 v[160:161], v[150:151], v[144:145], v[160:161] op_sel:[1,1,0] op_sel_hi:[0,1,1] neg_lo:[1,0,0]
    v_cvt_pk_f16_f32 v24, v114, -v115
    v_cvt_pk_f16_f32 v25, v160, -v161
    ds_write_b64 v33, v[24:25] offset:6864
    v_pk_mul_f32 v[116:117], v[104:105], v[100:101] op_sel_hi:[1,0]
    v_pk_fma_f32 v[116:117], v[104:105], v[100:101], v[116:117] op_sel:[1,1,0] op_sel_hi:[0,1,1] neg_lo:[1,0,0]
    v_pk_mul_f32 v[162:163], v[150:151], v[146:147] op_sel_hi:[1,0]
    v_pk_fma_f32 v[162:163], v[150:151], v[146:147], v[162:163] op_sel:[1,1,0] op_sel_hi:[0,1,1] neg_lo:[1,0,0]
    v_cvt_pk_f16_f32 v26, v116, -v117
    v_cvt_pk_f16_f32 v27, v162, -v163
    ds_write_b64 v33, v[26:27] offset:7392
    v_pk_mul_f32 v[112:113], v[104:105], v[102:103] op_sel_hi:[1,0]
    v_pk_fma_f32 v[112:113], v[104:105], v[102:103], v[112:113] op_sel:[1,1,0] op_sel_hi:[0,1,1] neg_lo:[1,0,0]
    v_pk_mul_f32 v[158:159], v[150:151], v[148:149] op_sel_hi:[1,0]
    v_pk_fma_f32 v[158:159], v[150:151], v[148:149], v[158:159] op_sel:[1,1,0] op_sel_hi:[0,1,1] neg_lo:[1,0,0]
    v_cvt_pk_f16_f32 v28, v112, -v113
    v_cvt_pk_f16_f32 v29, v158, -v159
    ds_write_b64 v33, v[28:29] offset:7920
    ds_read_b128 v[40:43], v34 offset:0
    ds_read_b128 v[44:47], v34 offset:64
    ds_read_b128 v[48:51], v34 offset:128
    ds_read_b128 v[52:55], v34 offset:192
    ds_read_b128 v[56:59], v34 offset:256
    ds_read_b128 v[60:63], v34 offset:320
    ds_read_b128 v[64:67], v34 offset:384
    ds_read_b128 v[68:71], v34 offset:448
    v_pk_mul_f32 v[78:79], v[76:77], v[76:77] op_sel_hi:[1,0]
    v_pk_fma_f32 v[78:79], v[76:77], v[76:77], v[78:79] op_sel:[1,1,0] op_sel_hi:[0,1,1] neg_lo:[1,0,0]
    v_pk_mul_f32 v[124:125], v[122:123], v[122:123] op_sel_hi:[1,0]
    v_pk_fma_f32 v[124:125], v[122:123], v[122:123], v[124:125] op_sel:[1,1,0] op_sel_hi:[0,1,1] neg_lo:[1,0,0]
    v_pk_mul_f32 v[80:81], v[76:77], v[78:79] op_sel_hi:[1,0]
    v_pk_fma_f32 v[80:81], v[76:77], v[78:79], v[80:81] op_sel:[1,1,0] op_sel_hi:[0,1,1] neg_lo:[1,0,0]
    v_pk_mul_f32 v[126:127], v[122:123], v[124:125] op_sel_hi:[1,0]
    v_pk_fma_f32 v[126:127], v[122:123], v[124:125], v[126:127] op_sel:[1,1,0] op_sel_hi:[0,1,1] neg_lo:[1,0,0]
    v_pk_mul_f32 v[82:83], v[78:79], v[78:79] op_sel_hi:[1,0]
    v_pk_fma_f32 v[82:83], v[78:79], v[78:79], v[82:83] op_sel:[1,1,0] op_sel_hi:[0,1,1] neg_lo:[1,0,0]
    v_pk_mul_f32 v[128:129], v[124:125], v[124:125] op_sel_hi:[1,0]
    v_pk_fma_f32 v[128:129], v[124:125], v[124:125], v[128:129] op_sel:[1,1,0] op_sel_hi:[0,1,1] neg_lo:[1,0,0]
    v_pk_mul_f32 v[84:85], v[78:79], v[80:81] op_sel_hi:[1,0]
    v_pk_fma_f32 v[84:85], v[78:79], v[80:81], v[84:85] op_sel:[1,1,0] op_sel_hi:[0,1,1] neg_lo:[1,0,0]
    v_pk_mul_f32 v[130:131], v[124:125], v[126:127] op_sel_hi:[1,0]
    v_pk_fma_f32 v[130:131], v[124:125], v[126:127], v[130:131] op_sel:[1,1,0] op_sel_hi:[0,1,1] neg_lo:[1,0,0]
    v_pk_mul_f32 v[86:87], v[80:81], v[80:81] op_sel_hi:[1,0]
    v_pk_fma_f32 v[86:87], v[80:81], v[80:81], v[86:87] op_sel:[1,1,0] op_sel_hi:[0,1,1] neg_lo:[1,0,0]
    v_pk_mul_f32 v[132:133], v[126:127], v[126:127] op_sel_hi:[1,0]
    v_pk_fma_f32 v[132:133], v[126:127], v[126:127], v[132:133] op_sel:[1,1,0] op_sel_hi:[0,1,1] neg_lo:[1,0,0]
    v_pk_mul_f32 v[88:89], v[80:81], v[82:83] op_sel_hi:[1,0]
    v_pk_fma_f32 v[88:89], v[80:81], v[82:83], v[88:89] op_sel:[1,1,0] op_sel_hi:[0,1,1] neg_lo:[1,0,0]
    v_pk_mul_f32 v[134:135], v[126:127], v[128:129] op_sel_hi:[1,0]
    v_pk_fma_f32 v[134:135], v[126:127], v[128:129], v[134:135] op_sel:[1,1,0] op_sel_hi:[0,1,1] neg_lo:[1,0,0]
    v_pk_mul_f32 v[108:109], v[74:75], v[106:107] op_sel_hi:[1,0]
    v_pk_fma_f32 v[108:109], v[74:75], v[106:107], v[108:109] op_sel:[1,1,0] op_sel_hi:[0,1,1] neg_lo:[1,0,0]
    v_pk_mul_f32 v[154:155], v[120:121], v[152:153] op_sel_hi:[1,0]
    v_pk_fma_f32 v[154:155], v[120:121], v[152:153], v[154:155] op_sel:[1,1,0] op_sel_hi:[0,1,1] neg_lo:[1,0,0]
    v_cvt_pk_f16_f32 v30, v74, v75
    v_cvt_pk_f16_f32 v31, v120, v121
    ds_write_b64 v33, v[30:31] offset:8448
    v_pk_mul_f32 v[112:113], v[74:75], v[76:77] op_sel_hi:[1,0]
    v_pk_fma_f32 v[112:113], v[74:75], v[76:77], v[112:113] op_sel:[1,1,0] op_sel_hi:[0,1,1] neg_lo:[1,0,0]
    v_pk_mul_f32 v[158:159], v[120:121], v[122:123] op_sel_hi:[1,0]
    v_pk_fma_f32 v[158:159], v[120:121], v[122:123], v[158:159] op_sel:[1,1,0] op_sel_hi:[0,1,1] neg_lo:[1,0,0]
    v_cvt_pk_f16_f32 v24, v112, v113
    v_cvt_pk_f16_f32 v25, v158, v159
    ds_write_b64 v33, v[24:25] offset:8976
    v_pk_mul_f32 v[114:115], v[74:75], v[78:79] op_sel_hi:[1,0]
    v_pk_fma_f32 v[114:115], v[74:75], v[78:79], v[114:115] op_sel:[1,1,0] op_sel_hi:[0,1,1] neg_lo:[1,0,0]
    v_pk_mul_f32 v[160:161], v[120:121], v[124:125] op_sel_hi:[1,0]
    v_pk_fma_f32 v[160:161], v[120:121], v[124:125], v[160:161] op_sel:[1,1,0] op_sel_hi:[0,1,1] neg_lo:[1,0,0]
    v_cvt_pk_f16_f32 v26, v114, v115
    v_cvt_pk_f16_f32 v27, v160, v161
    ds_write_b64 v33, v[26:27] offset:9504
    v_pk_mul_f32 v[116:117], v[74:75], v[80:81] op_sel_hi:[1,0]
    v_pk_fma_f32 v[116:117], v[74:75], v[80:81], v[116:117] op_sel:[1,1,0] op_sel_hi:[0,1,1] neg_lo:[1,0,0]
    v_pk_mul_f32 v[162:163], v[120:121], v[126:127] op_sel_hi:[1,0]
    v_pk_fma_f32 v[162:163], v[120:121], v[126:127], v[162:163] op_sel:[1,1,0] op_sel_hi:[0,1,1] neg_lo:[1,0,0]
    v_cvt_pk_f16_f32 v28, v116, v117
    v_cvt_pk_f16_f32 v29, v162, v163
    ds_write_b64 v33, v[28:29] offset:10032
    v_pk_mul_f32 v[112:113], v[74:75], v[82:83] op_sel_hi:[1,0]
    v_pk_fma_f32 v[112:113], v[74:75], v[82:83], v[112:113] op_sel:[1,1,0] op_sel_hi:[0,1,1] neg_lo:[1,0,0]
    v_pk_mul_f32 v[158:159], v[120:121], v[128:129] op_sel_hi:[1,0]
    v_pk_fma_f32 v[158:159], v[120:121], v[128:129], v[158:159] op_sel:[1,1,0] op_sel_hi:[0,1,1] neg_lo:[1,0,0]
    v_cvt_pk_f16_f32 v30, v112, v113
    v_cvt_pk_f16_f32 v31, v158, v159
    ds_write_b64 v33, v[30:31] offset:10560
    v_pk_mul_f32 v[114:115], v[74:75], v[84:85] op_sel_hi:[1,0]
    v_pk_fma_f32 v[114:115], v[74:75], v[84:85], v[114:115] op_sel:[1,1,0] op_sel_hi:[0,1,1] neg_lo:[1,0,0]
    v_pk_mul_f32 v[160:161], v[120:121], v[130:131] op_sel_hi:[1,0]
    v_pk_fma_f32 v[160:161], v[120:121], v[130:131], v[160:161] op_sel:[1,1,0] op_sel_hi:[0,1,1] neg_lo:[1,0,0]
    v_cvt_pk_f16_f32 v24, v114, v115
    v_cvt_pk_f16_f32 v25, v160, v161
    ds_write_b64 v33, v[24:25] offset:11088
    v_pk_mul_f32 v[116:117], v[74:75], v[86:87] op_sel_hi:[1,0]
    v_pk_fma_f32 v[116:117], v[74:75], v[86:87], v[116:117] op_sel:[1,1,0] op_sel_hi:[0,1,1] neg_lo:[1,0,0]
    v_pk_mul_f32 v[162:163], v[120:121], v[132:133] op_sel_hi:[1,0]
    v_pk_fma_f32 v[162:163], v[120:121], v[132:133], v[162:163] op_sel:[1,1,0] op_sel_hi:[0,1,1] neg_lo:[1,0,0]
    v_cvt_pk_f16_f32 v26, v116, v117
    v_cvt_pk_f16_f32 v27, v162, v163
    ds_write_b64 v33, v[26:27] offset:11616
    v_pk_mul_f32 v[112:113], v[74:75], v[88:89] op_sel_hi:[1,0]
    v_pk_fma_f32 v[112:113], v[74:75], v[88:89], v[112:113] op_sel:[1,1,0] op_sel_hi:[0,1,1] neg_lo:[1,0,0]
    v_pk_mul_f32 v[158:159], v[120:121], v[134:135] op_sel_hi:[1,0]
    v_pk_fma_f32 v[158:159], v[120:121], v[134:135], v[158:159] op_sel:[1,1,0] op_sel_hi:[0,1,1] neg_lo:[1,0,0]
    v_cvt_pk_f16_f32 v28, v112, v113
    v_cvt_pk_f16_f32 v29, v158, v159
    ds_write_b64 v33, v[28:29] offset:12144
    v_pk_mul_f32 v[110:111], v[108:109], v[106:107] op_sel_hi:[1,0]
    v_pk_fma_f32 v[110:111], v[108:109], v[106:107], v[110:111] op_sel:[1,1,0] op_sel_hi:[0,1,1] neg_lo:[1,0,0]
    v_pk_mul_f32 v[156:157], v[154:155], v[152:153] op_sel_hi:[1,0]
    v_pk_fma_f32 v[156:157], v[154:155], v[152:153], v[156:157] op_sel:[1,1,0] op_sel_hi:[0,1,1] neg_lo:[1,0,0]
    v_cvt_pk_f16_f32 v30, v108, v109
    v_cvt_pk_f16_f32 v31, v154, v155
    ds_write_b64 v33, v[30:31] offset:12672
    v_pk_mul_f32 v[114:115], v[108:109], v[76:77] op_sel_hi:[1,0]
    v_pk_fma_f32 v[114:115], v[108:109], v[76:77], v[114:115] op_sel:[1,1,0] op_sel_hi:[0,1,1] neg_lo:[1,0,0]
    v_pk_mul_f32 v[160:161], v[154:155], v[122:123] op_sel_hi:[1,0]
    v_pk_fma_f32 v[160:161], v[154:155], v[122:123], v[160:161] op_sel:[1,1,0] op_sel_hi:[0,1,1] neg_lo:[1,0,0]
    v_cvt_pk_f16_f32 v24, v114, v115
    v_cvt_pk_f16_f32 v25, v160, v161
    ds_write_b64 v33, v[24:25] offset:13200
    v_pk_mul_f32 v[116:117], v[108:109], v[78:79] op_sel_hi:[1,0]
    v_pk_fma_f32 v[116:117], v[108:109], v[78:79], v[116:117] op_sel:[1,1,0] op_sel_hi:[0,1,1] neg_lo:[1,0,0]
    v_pk_mul_f32 v[162:163], v[154:155], v[124:125] op_sel_hi:[1,0]
    v_pk_fma_f32 v[162:163], v[154:155], v[124:125], v[162:163] op_sel:[1,1,0] op_sel_hi:[0,1,1] neg_lo:[1,0,0]
    v_cvt_pk_f16_f32 v26, v116, v117
    v_cvt_pk_f16_f32 v27, v162, v163
    ds_write_b64 v33, v[26:27] offset:13728
    v_pk_mul_f32 v[112:113], v[108:109], v[80:81] op_sel_hi:[1,0]
    v_pk_fma_f32 v[112:113], v[108:109], v[80:81], v[112:113] op_sel:[1,1,0] op_sel_hi:[0,1,1] neg_lo:[1,0,0]
    v_pk_mul_f32 v[158:159], v[154:155], v[126:127] op_sel_hi:[1,0]
    v_pk_fma_f32 v[158:159], v[154:155], v[126:127], v[158:159] op_sel:[1,1,0] op_sel_hi:[0,1,1] neg_lo:[1,0,0]
    v_cvt_pk_f16_f32 v28, v112, v113
    v_cvt_pk_f16_f32 v29, v158, v159
    ds_write_b64 v33, v[28:29] offset:14256
    v_pk_mul_f32 v[114:115], v[108:109], v[82:83] op_sel_hi:[1,0]
    v_pk_fma_f32 v[114:115], v[108:109], v[82:83], v[114:115] op_sel:[1,1,0] op_sel_hi:[0,1,1] neg_lo:[1,0,0]
    v_pk_mul_f32 v[160:161], v[154:155], v[128:129] op_sel_hi:[1,0]
    v_pk_fma_f32 v[160:161], v[154:155], v[128:129], v[160:161] op_sel:[1,1,0] op_sel_hi:[0,1,1] neg_lo:[1,0,0]
    v_cvt_pk_f16_f32 v30, v114, v115
    v_cvt_pk_f16_f32 v31, v160, v161
    ds_write_b64 v33, v[30:31] offset:14784
    v_pk_mul_f32 v[116:117], v[108:109], v[84:85] op_sel_hi:[1,0]
    v_pk_fma_f32 v[116:117], v[108:109], v[84:85], v[116:117] op_sel:[1,1,0] op_sel_hi:[0,1,1] neg_lo:[1,0,0]
    v_pk_mul_f32 v[162:163], v[154:155], v[130:131] op_sel_hi:[1,0]
    v_pk_fma_f32 v[162:163], v[154:155], v[130:131], v[162:163] op_sel:[1,1,0] op_sel_hi:[0,1,1] neg_lo:[1,0,0]
    v_cvt_pk_f16_f32 v24, v116, v117
    v_cvt_pk_f16_f32 v25, v162, v163
    ds_write_b64 v33, v[24:25] offset:15312
    v_pk_mul_f32 v[112:113], v[108:109], v[86:87] op_sel_hi:[1,0]
    v_pk_fma_f32 v[112:113], v[108:109], v[86:87], v[112:113] op_sel:[1,1,0] op_sel_hi:[0,1,1] neg_lo:[1,0,0]
    v_pk_mul_f32 v[158:159], v[154:155], v[132:133] op_sel_hi:[1,0]
    v_pk_fma_f32 v[158:159], v[154:155], v[132:133], v[158:159] op_sel:[1,1,0] op_sel_hi:[0,1,1] neg_lo:[1,0,0]
    v_cvt_pk_f16_f32 v26, v112, v113
    v_cvt_pk_f16_f32 v27, v158, v159
    ds_write_b64 v33, v[26:27] offset:15840
    v_pk_mul_f32 v[114:115], v[108:109], v[88:89] op_sel_hi:[1,0]
    v_pk_fma_f32 v[114:115], v[108:109], v[88:89], v[114:115] op_sel:[1,1,0] op_sel_hi:[0,1,1] neg_lo:[1,0,0]
    v_pk_mul_f32 v[160:161], v[154:155], v[134:135] op_sel_hi:[1,0]
    v_pk_fma_f32 v[160:161], v[154:155], v[134:135], v[160:161] op_sel:[1,1,0] op_sel_hi:[0,1,1] neg_lo:[1,0,0]
    v_cvt_pk_f16_f32 v28, v114, v115
    v_cvt_pk_f16_f32 v29, v160, v161
    ds_write_b64 v33, v[28:29] offset:16368
    ds_read_b128 v[90:93], v34 offset:8448
    ds_read_b128 v[94:97], v34 offset:8512
    ds_read_b128 v[98:101], v34 offset:8576
    ds_read_b128 v[102:105], v34 offset:8640
    ds_read_b128 v[136:139], v34 offset:8704
    ds_read_b128 v[140:143], v34 offset:8768
    ds_read_b128 v[144:147], v34 offset:8832
    ds_read_b128 v[148:151], v34 offset:8896
    v_pk_mul_f32 v[108:109], v[110:111], v[106:107] op_sel_hi:[1,0]
    v_pk_fma_f32 v[108:109], v[110:111], v[106:107], v[108:109] op_sel:[1,1,0] op_sel_hi:[0,1,1] neg_lo:[1,0,0]
    v_pk_mul_f32 v[154:155], v[156:157], v[152:153] op_sel_hi:[1,0]
    v_pk_fma_f32 v[154:155], v[156:157], v[152:153], v[154:155] op_sel:[1,1,0] op_sel_hi:[0,1,1] neg_lo:[1,0,0]
    v_cvt_pk_f16_f32 v30, v110, v111
    v_cvt_pk_f16_f32 v31, v156, v157
    ds_write_b64 v33, v[30:31] offset:0
    v_pk_mul_f32 v[116:117], v[110:111], v[78:79] op_sel_hi:[1,0]
    v_pk_fma_f32 v[116:117], v[110:111], v[78:79], v[116:117] op_sel:[1,1,0] op_sel_hi:[0,1,1] neg_lo:[1,0,0]
    v_pk_mul_f32 v[162:163], v[156:157], v[124:125] op_sel_hi:[1,0]
    v_pk_fma_f32 v[162:163], v[156:157], v[124:125], v[162:163] op_sel:[1,1,0] op_sel_hi:[0,1,1] neg_lo:[1,0,0]
    v_cvt_pk_f16_f32 v24, v116, v117
    v_cvt_pk_f16_f32 v25, v162, v163
    ds_write_b64 v33, v[24:25] offset:528
    v_pk_mul_f32 v[112:113], v[110:111], v[82:83] op_sel_hi:[1,0]
    v_pk_fma_f32 v[112:113], v[110:111], v[82:83], v[112:113] op_sel:[1,1,0] op_sel_hi:[0,1,1] neg_lo:[1,0,0]
    v_pk_mul_f32 v[158:159], v[156:157], v[128:129] op_sel_hi:[1,0]
    v_pk_fma_f32 v[158:159], v[156:157], v[128:129], v[158:159] op_sel:[1,1,0] op_sel_hi:[0,1,1] neg_lo:[1,0,0]
    v_cvt_pk_f16_f32 v26, v112, v113
    v_cvt_pk_f16_f32 v27, v158, v159
    ds_write_b64 v33, v[26:27] offset:1056
    v_pk_mul_f32 v[114:115], v[110:111], v[86:87] op_sel_hi:[1,0]
    v_pk_fma_f32 v[114:115], v[110:111], v[86:87], v[114:115] op_sel:[1,1,0] op_sel_hi:[0,1,1] neg_lo:[1,0,0]
    v_pk_mul_f32 v[160:161], v[156:157], v[132:133] op_sel_hi:[1,0]
    v_pk_fma_f32 v[160:161], v[156:157], v[132:133], v[160:161] op_sel:[1,1,0] op_sel_hi:[0,1,1] neg_lo:[1,0,0]
    v_cvt_pk_f16_f32 v28, v114, v115
    v_cvt_pk_f16_f32 v29, v160, v161
    ds_write_b64 v33, v[28:29] offset:1584
    v_pk_mul_f32 v[110:111], v[108:109], v[106:107] op_sel_hi:[1,0]
    v_pk_fma_f32 v[110:111], v[108:109], v[106:107], v[110:111] op_sel:[1,1,0] op_sel_hi:[0,1,1] neg_lo:[1,0,0]
    v_pk_mul_f32 v[156:157], v[154:155], v[152:153] op_sel_hi:[1,0]
    v_pk_fma_f32 v[156:157], v[154:155], v[152:153], v[156:157] op_sel:[1,1,0] op_sel_hi:[0,1,1] neg_lo:[1,0,0]
    v_cvt_pk_f16_f32 v30, v108, v109
    v_cvt_pk_f16_f32 v31, v154, v155
    ds_write_b64 v33, v[30:31] offset:2112
    v_pk_mul_f32 v[116:117], v[108:109], v[78:79] op_sel_hi:[1,0]
    v_pk_fma_f32 v[116:117], v[108:109], v[78:79], v[116:117] op_sel:[1,1,0] op_sel_hi:[0,1,1] neg_lo:[1,0,0]
    v_pk_mul_f32 v[162:163], v[154:155], v[124:125] op_sel_hi:[1,0]
    v_pk_fma_f32 v[162:163], v[154:155], v[124:125], v[162:163] op_sel:[1,1,0] op_sel_hi:[0,1,1] neg_lo:[1,0,0]
    v_cvt_pk_f16_f32 v24, v116, v117
    v_cvt_pk_f16_f32 v25, v162, v163
    ds_write_b64 v33, v[24:25] offset:2640
    v_pk_mul_f32 v[112:113], v[108:109], v[82:83] op_sel_hi:[1,0]
    v_pk_fma_f32 v[112:113], v[108:109], v[82:83], v[112:113] op_sel:[1,1,0] op_sel_hi:[0,1,1] neg_lo:[1,0,0]
    v_pk_mul_f32 v[158:159], v[154:155], v[128:129] op_sel_hi:[1,0]
    v_pk_fma_f32 v[158:159], v[154:155], v[128:129], v[158:159] op_sel:[1,1,0] op_sel_hi:[0,1,1] neg_lo:[1,0,0]
    v_cvt_pk_f16_f32 v26, v112, v113
    v_cvt_pk_f16_f32 v27, v158, v159
    ds_write_b64 v33, v[26:27] offset:3168
    s_waitcnt lgkmcnt(7)
    v_mfma_f32_16x16x32_f16 v[8:11], v[90:93], v[40:43], 0
    v_pk_mul_f32 v[114:115], v[108:109], v[86:87] op_sel_hi:[1,0]
    v_pk_fma_f32 v[114:115], v[108:109], v[86:87], v[114:115] op_sel:[1,1,0] op_sel_hi:[0,1,1] neg_lo:[1,0,0]
    v_pk_mul_f32 v[160:161], v[154:155], v[132:133] op_sel_hi:[1,0]
    v_pk_fma_f32 v[160:161], v[154:155], v[132:133], v[160:161] op_sel:[1,1,0] op_sel_hi:[0,1,1] neg_lo:[1,0,0]
    v_cvt_pk_f16_f32 v28, v114, v115
    v_cvt_pk_f16_f32 v29, v160, v161
    ds_write_b64 v33, v[28:29] offset:3696
    v_mfma_f32_16x16x32_f16 v[8:11], v[94:97], v[44:47], v[8:11]
    v_pk_mul_f32 v[108:109], v[110:111], v[106:107] op_sel_hi:[1,0]
    v_pk_fma_f32 v[108:109], v[110:111], v[106:107], v[108:109] op_sel:[1,1,0] op_sel_hi:[0,1,1] neg_lo:[1,0,0]
    v_pk_mul_f32 v[154:155], v[156:157], v[152:153] op_sel_hi:[1,0]
    v_pk_fma_f32 v[154:155], v[156:157], v[152:153], v[154:155] op_sel:[1,1,0] op_sel_hi:[0,1,1] neg_lo:[1,0,0]
    v_cvt_pk_f16_f32 v30, v110, v111
    v_cvt_pk_f16_f32 v31, v156, v157
    ds_write_b64 v33, v[30:31] offset:4224
    v_mfma_f32_16x16x32_f16 v[8:11], v[98:101], v[48:51], v[8:11]
    v_pk_mul_f32 v[116:117], v[110:111], v[82:83] op_sel_hi:[1,0]
    v_pk_fma_f32 v[116:117], v[110:111], v[82:83], v[116:117] op_sel:[1,1,0] op_sel_hi:[0,1,1] neg_lo:[1,0,0]
    v_pk_mul_f32 v[162:163], v[156:157], v[128:129] op_sel_hi:[1,0]
    v_pk_fma_f32 v[162:163], v[156:157], v[128:129], v[162:163] op_sel:[1,1,0] op_sel_hi:[0,1,1] neg_lo:[1,0,0]
    v_cvt_pk_f16_f32 v24, v116, v117
    v_cvt_pk_f16_f32 v25, v162, v163
    ds_write_b64 v33, v[24:25] offset:4752
    v_mfma_f32_16x16x32_f16 v[8:11], v[102:105], v[52:55], v[8:11]
    v_pk_mul_f32 v[110:111], v[108:109], v[106:107] op_sel_hi:[1,0]
    v_pk_fma_f32 v[110:111], v[108:109], v[106:107], v[110:111] op_sel:[1,1,0] op_sel_hi:[0,1,1] neg_lo:[1,0,0]
    v_pk_mul_f32 v[156:157], v[154:155], v[152:153] op_sel_hi:[1,0]
    v_pk_fma_f32 v[156:157], v[154:155], v[152:153], v[156:157] op_sel:[1,1,0] op_sel_hi:[0,1,1] neg_lo:[1,0,0]
    v_cvt_pk_f16_f32 v26, v108, v109
    v_cvt_pk_f16_f32 v27, v154, v155
    ds_write_b64 v33, v[26:27] offset:5280
    v_mfma_f32_16x16x32_f16 v[8:11], v[136:139], v[56:59], v[8:11]
    v_pk_mul_f32 v[112:113], v[108:109], v[82:83] op_sel_hi:[1,0]
    v_pk_fma_f32 v[112:113], v[108:109], v[82:83], v[112:113] op_sel:[1,1,0] op_sel_hi:[0,1,1] neg_lo:[1,0,0]
    v_pk_mul_f32 v[158:159], v[154:155], v[128:129] op_sel_hi:[1,0]
    v_pk_fma_f32 v[158:159], v[154:155], v[128:129], v[158:159] op_sel:[1,1,0] op_sel_hi:[0,1,1] neg_lo:[1,0,0]
    v_cvt_pk_f16_f32 v28, v112, v113
    v_cvt_pk_f16_f32 v29, v158, v159
    ds_write_b64 v33, v[28:29] offset:5808
    v_mfma_f32_16x16x32_f16 v[8:11], v[140:143], v[60:63], v[8:11]
    v_pk_mul_f32 v[108:109], v[110:111], v[106:107] op_sel_hi:[1,0]
    v_pk_fma_f32 v[108:109], v[110:111], v[106:107], v[108:109] op_sel:[1,1,0] op_sel_hi:[0,1,1] neg_lo:[1,0,0]
    v_pk_mul_f32 v[154:155], v[156:157], v[152:153] op_sel_hi:[1,0]
    v_pk_fma_f32 v[154:155], v[156:157], v[152:153], v[154:155] op_sel:[1,1,0] op_sel_hi:[0,1,1] neg_lo:[1,0,0]
    v_cvt_pk_f16_f32 v30, v110, v111
    v_cvt_pk_f16_f32 v31, v156, v157
    ds_write_b64 v33, v[30:31] offset:6336
    v_mfma_f32_16x16x32_f16 v[8:11], v[144:147], v[64:67], v[8:11]
    v_pk_mul_f32 v[114:115], v[110:111], v[82:83] op_sel_hi:[1,0]
    v_pk_fma_f32 v[114:115], v[110:111], v[82:83], v[114:115] op_sel:[1,1,0] op_sel_hi:[0,1,1] neg_lo:[1,0,0]
    v_pk_mul_f32 v[160:161], v[156:157], v[128:129] op_sel_hi:[1,0]
    v_pk_fma_f32 v[160:161], v[156:157], v[128:129], v[160:161] op_sel:[1,1,0] op_sel_hi:[0,1,1] neg_lo:[1,0,0]
    v_cvt_pk_f16_f32 v24, v114, v115
    v_cvt_pk_f16_f32 v25, v160, v161
    ds_write_b64 v33, v[24:25] offset:6864
    v_mfma_f32_16x16x32_f16 v[8:11], v[148:151], v[68:71], v[8:11]
    v_pk_mul_f32 v[110:111], v[108:109], v[106:107] op_sel_hi:[1,0]
    v_pk_fma_f32 v[110:111], v[108:109], v[106:107], v[110:111] op_sel:[1,1,0] op_sel_hi:[0,1,1] neg_lo:[1,0,0]
    v_pk_mul_f32 v[156:157], v[154:155], v[152:153] op_sel_hi:[1,0]
    v_pk_fma_f32 v[156:157], v[154:155], v[152:153], v[156:157] op_sel:[1,1,0] op_sel_hi:[0,1,1] neg_lo:[1,0,0]
    v_cvt_pk_f16_f32 v26, v108, v109
    v_cvt_pk_f16_f32 v27, v154, v155
    ds_write_b64 v33, v[26:27] offset:7392
    v_pk_mul_f32 v[116:117], v[108:109], v[82:83] op_sel_hi:[1,0]
    v_pk_fma_f32 v[116:117], v[108:109], v[82:83], v[116:117] op_sel:[1,1,0] op_sel_hi:[0,1,1] neg_lo:[1,0,0]
    v_pk_mul_f32 v[162:163], v[154:155], v[128:129] op_sel_hi:[1,0]
    v_pk_fma_f32 v[162:163], v[154:155], v[128:129], v[162:163] op_sel:[1,1,0] op_sel_hi:[0,1,1] neg_lo:[1,0,0]
    v_cvt_pk_f16_f32 v28, v116, v117
    v_cvt_pk_f16_f32 v29, v162, v163
    ds_write_b64 v33, v[28:29] offset:7920
    ds_read_b128 v[90:93], v34 offset:0
    ds_read_b128 v[94:97], v34 offset:64
    ds_read_b128 v[98:101], v34 offset:128
    ds_read_b128 v[102:105], v34 offset:192
    ds_read_b128 v[136:139], v34 offset:256
    ds_read_b128 v[140:143], v34 offset:320
    ds_read_b128 v[144:147], v34 offset:384
    ds_read_b128 v[148:151], v34 offset:448
    v_pk_mul_f32 v[108:109], v[110:111], v[106:107] op_sel_hi:[1,0]
    v_pk_fma_f32 v[108:109], v[110:111], v[106:107], v[108:109] op_sel:[1,1,0] op_sel_hi:[0,1,1] neg_lo:[1,0,0]
    v_pk_mul_f32 v[154:155], v[156:157], v[152:153] op_sel_hi:[1,0]
    v_pk_fma_f32 v[154:155], v[156:157], v[152:153], v[154:155] op_sel:[1,1,0] op_sel_hi:[0,1,1] neg_lo:[1,0,0]
    v_cvt_pk_f16_f32 v30, v110, v111
    v_cvt_pk_f16_f32 v31, v156, v157
    ds_write_b64 v33, v[30:31] offset:8448
    v_pk_mul_f32 v[110:111], v[108:109], v[106:107] op_sel_hi:[1,0]
    v_pk_fma_f32 v[110:111], v[108:109], v[106:107], v[110:111] op_sel:[1,1,0] op_sel_hi:[0,1,1] neg_lo:[1,0,0]
    v_pk_mul_f32 v[156:157], v[154:155], v[152:153] op_sel_hi:[1,0]
    v_pk_fma_f32 v[156:157], v[154:155], v[152:153], v[156:157] op_sel:[1,1,0] op_sel_hi:[0,1,1] neg_lo:[1,0,0]
    v_cvt_pk_f16_f32 v24, v108, v109
    v_cvt_pk_f16_f32 v25, v154, v155
    ds_write_b64 v33, v[24:25] offset:8976
    v_pk_mul_f32 v[108:109], v[110:111], v[106:107] op_sel_hi:[1,0]
    v_pk_fma_f32 v[108:109], v[110:111], v[106:107], v[108:109] op_sel:[1,1,0] op_sel_hi:[0,1,1] neg_lo:[1,0,0]
    v_pk_mul_f32 v[154:155], v[156:157], v[152:153] op_sel_hi:[1,0]
    v_pk_fma_f32 v[154:155], v[156:157], v[152:153], v[154:155] op_sel:[1,1,0] op_sel_hi:[0,1,1] neg_lo:[1,0,0]
    v_cvt_pk_f16_f32 v26, v110, v111
    v_cvt_pk_f16_f32 v27, v156, v157
    ds_write_b64 v33, v[26:27] offset:9504
    v_pk_mul_f32 v[110:111], v[108:109], v[106:107] op_sel_hi:[1,0]
    v_pk_fma_f32 v[110:111], v[108:109], v[106:107], v[110:111] op_sel:[1,1,0] op_sel_hi:[0,1,1] neg_lo:[1,0,0]
    v_pk_mul_f32 v[156:157], v[154:155], v[152:153] op_sel_hi:[1,0]
    v_pk_fma_f32 v[156:157], v[154:155], v[152:153], v[156:157] op_sel:[1,1,0] op_sel_hi:[0,1,1] neg_lo:[1,0,0]
    v_cvt_pk_f16_f32 v28, v108, v109
    v_cvt_pk_f16_f32 v29, v154, v155
    ds_write_b64 v33, v[28:29] offset:10032
    v_pk_mul_f32 v[108:109], v[110:111], v[106:107] op_sel_hi:[1,0]
    v_pk_fma_f32 v[108:109], v[110:111], v[106:107], v[108:109] op_sel:[1,1,0] op_sel_hi:[0,1,1] neg_lo:[1,0,0]
    v_pk_mul_f32 v[154:155], v[156:157], v[152:153] op_sel_hi:[1,0]
    v_pk_fma_f32 v[154:155], v[156:157], v[152:153], v[154:155] op_sel:[1,1,0] op_sel_hi:[0,1,1] neg_lo:[1,0,0]
    v_cvt_pk_f16_f32 v30, v110, v111
    v_cvt_pk_f16_f32 v31, v156, v157
    ds_write_b64 v33, v[30:31] offset:10560
    v_pk_mul_f32 v[110:111], v[108:109], v[106:107] op_sel_hi:[1,0]
    v_pk_fma_f32 v[110:111], v[108:109], v[106:107], v[110:111] op_sel:[1,1,0] op_sel_hi:[0,1,1] neg_lo:[1,0,0]
    v_pk_mul_f32 v[156:157], v[154:155], v[152:153] op_sel_hi:[1,0]
    v_pk_fma_f32 v[156:157], v[154:155], v[152:153], v[156:157] op_sel:[1,1,0] op_sel_hi:[0,1,1] neg_lo:[1,0,0]
    v_cvt_pk_f16_f32 v24, v108, v109
    v_cvt_pk_f16_f32 v25, v154, v155
    ds_write_b64 v33, v[24:25] offset:11088
    v_pk_mul_f32 v[108:109], v[110:111], v[106:107] op_sel_hi:[1,0]
    v_pk_fma_f32 v[108:109], v[110:111], v[106:107], v[108:109] op_sel:[1,1,0] op_sel_hi:[0,1,1] neg_lo:[1,0,0]
    v_pk_mul_f32 v[154:155], v[156:157], v[152:153] op_sel_hi:[1,0]
    v_pk_fma_f32 v[154:155], v[156:157], v[152:153], v[154:155] op_sel:[1,1,0] op_sel_hi:[0,1,1] neg_lo:[1,0,0]
    v_cvt_pk_f16_f32 v26, v110, v111
    v_cvt_pk_f16_f32 v27, v156, v157
    ds_write_b64 v33, v[26:27] offset:11616
    v_pk_mul_f32 v[110:111], v[108:109], v[106:107] op_sel_hi:[1,0]
    v_pk_fma_f32 v[110:111], v[108:109], v[106:107], v[110:111] op_sel:[1,1,0] op_sel_hi:[0,1,1] neg_lo:[1,0,0]
    v_pk_mul_f32 v[156:157], v[154:155], v[152:153] op_sel_hi:[1,0]
    v_pk_fma_f32 v[156:157], v[154:155], v[152:153], v[156:157] op_sel:[1,1,0] op_sel_hi:[0,1,1] neg_lo:[1,0,0]
    v_cvt_pk_f16_f32 v28, v108, v109
    v_cvt_pk_f16_f32 v29, v154, v155
    ds_write_b64 v33, v[28:29] offset:12144
    v_cvt_pk_f16_f32 v30, v110, v111
    v_cvt_pk_f16_f32 v31, v156, v157
    ds_write_b64 v33, v[30:31] offset:12672
    ds_read_b128 v[74:77], v34 offset:8448
    ds_read_b128 v[78:81], v34 offset:8512
    ds_read_b128 v[82:85], v34 offset:8576
    ds_read_b128 v[86:89], v34 offset:8640
    ds_read_b128 v[120:123], v34 offset:8704
    ds_read_b128 v[124:127], v34 offset:8768
    ds_read_b128 v[128:131], v34 offset:8832
    ds_read_b128 v[132:135], v34 offset:8896
    v_and_b32 v32, 15, v1
    s_mul_i32 s100, s40, 16896
    v_lshrrev_b32 v164, 1, v35
    v_lshlrev_b32 v164, 7, v164
    v_and_b32 v165, 1, v35
    v_lshl_add_u32 v164, v165, 2, v164
    v_lshl_add_u32 v164, v32, 3, v164
    v_lshl_add_u32 v164, v164, 1, s100
    v_lshlrev_b32 v167, 6, v35
    v_cmp_gt_u32 vcc, 2, v35
    v_lshlrev_b32 v165, 2, v32
    v_lshlrev_b32 v166, 1, v32
    v_cndmask_b32 v165, v166, v165, vcc
    s_waitcnt lgkmcnt(8)
    v_mfma_f32_16x16x32_f16 v[12:15], v[90:93], v[40:43], 0
    v_mfma_f32_16x16x32_f16 v[12:15], v[94:97], v[44:47], v[12:15]
    v_mfma_f32_16x16x32_f16 v[12:15], v[98:101], v[48:51], v[12:15]
    v_mfma_f32_16x16x32_f16 v[12:15], v[102:105], v[52:55], v[12:15]
    v_mfma_f32_16x16x32_f16 v[12:15], v[136:139], v[56:59], v[12:15]
    v_mfma_f32_16x16x32_f16 v[12:15], v[140:143], v[60:63], v[12:15]
    v_mfma_f32_16x16x32_f16 v[12:15], v[144:147], v[64:67], v[12:15]
    v_mfma_f32_16x16x32_f16 v[12:15], v[148:151], v[68:71], v[12:15]
    s_waitcnt lgkmcnt(0)
    v_mfma_f32_16x16x32_f16 v[16:19], v[74:77], v[40:43], 0
    v_mfma_f32_16x16x32_f16 v[16:19], v[78:81], v[44:47], v[16:19]
    v_mfma_f32_16x16x32_f16 v[16:19], v[82:85], v[48:51], v[16:19]
    v_mfma_f32_16x16x32_f16 v[16:19], v[86:89], v[52:55], v[16:19]
    v_mfma_f32_16x16x32_f16 v[16:19], v[120:123], v[56:59], v[16:19]
    v_mfma_f32_16x16x32_f16 v[16:19], v[124:127], v[60:63], v[16:19]
    v_mfma_f32_16x16x32_f16 v[16:19], v[128:131], v[64:67], v[16:19]
    v_mfma_f32_16x16x32_f16 v[16:19], v[132:135], v[68:71], v[16:19]
    v_add_u32 v165, v165, v167
    v_add_u32 v165, 256, v165
    v_mov_b32 v166, 32
    v_cndmask_b32 v166, v166, 2, vcc
    v_add_u32 v166, v166, v165
    v_lshl_add_u32 v165, v165, 1, s100
    v_lshl_add_u32 v166, v166, 1, s100
    v_add3_u32 v167, v167, v32, 64
    v_add_u32 v167, 448, v167
    v_lshl_add_u32 v167, v167, 1, s100
    v_mul_f32 v8, s22, v8
    v_mul_f32 v9, s22, v9
    v_mul_f32 v10, s22, v10
    v_mul_f32 v11, s22, v11
    v_mul_f32 v12, s22, v12
    v_mul_f32 v13, s22, v13
    v_mul_f32 v14, s22, v14
    v_mul_f32 v15, s22, v15
    v_mul_f32 v16, s22, v16
    v_mul_f32 v17, s22, v17
    v_mul_f32 v18, s22, v18
    v_mul_f32 v19, s22, v19
    v_cvt_pk_bf16_f32 v20, v8, v9
    v_cvt_pk_bf16_f32 v21, v10, v11
    v_cvt_pk_bf16_f32 v22, v12, v13
    v_cvt_pk_bf16_f32 v23, v14, v15
    v_cvt_pk_bf16_f32 v24, v16, v17
    v_cvt_pk_bf16_f32 v25, v18, v19
    ds_write_b64 v164, v[20:21] offset:0
    ds_write_b32 v165, v22 offset:0
    ds_write_b32 v166, v23 offset:0
    ds_write_b16 v167, v24 offset:0
    ds_write_b16_d16_hi v167, v24 offset:32
    ds_write_b16 v167, v25 offset:64
    ds_write_b16_d16_hi v167, v25 offset:96
    s_mul_i32 s99, s40, 16896
    v_lshl_add_u32 v37, v1, 4, s99
    v_lshl_add_u32 v32, v1, 4, s100
    v_lshl_add_u32 v33, v1, 3, s100
    v_lshl_add_u32 v34, v1, 2, s100
    v_lshl_add_u32 v35, v1, 1, s100
    s_mov_b32 s26, 0x01000100
    s_mov_b32 s27, 0x03020302
    ds_read_b128 v[40:43], v32
    ds_read_b64 v[44:45], v32 offset:16
    ds_read_b64 v[72:73], v33 offset:256
    ds_read_b32 v74, v33 offset:264
    ds_read_b32 v76, v34 offset:768
    ds_read_b32 v77, v34 offset:772
    ds_read_u16 v78, v35 offset:1024
    ds_read_u16 v79, v35 offset:1026
    ds_read_u16 v80, v35 offset:1152
    ds_read_u16 v81, v35 offset:1154
    v_and_b32 v32, 1, v1
    v_cmp_eq_u32 vcc, 0, v32
    s_waitcnt lgkmcnt(0)
    s_mov_b32 exec_hi, 0
    s_mov_b32 exec_lo, 0x80000000
    v_lshrrev_b32 v45, 16, v44
    v_perm_b32 v44, v44, v44, s26
    s_mov_b32 exec_lo, 0
    s_mov_b32 exec_hi, -1
    v_perm_b32 v40, v72, v72, s26
    v_alignbit_b32 v41, v73, v72, 16
    v_perm_b32 v42, v73, v73, s26
    v_alignbit_b32 v43, v74, v73, 16
    v_perm_b32 v44, v74, v74, s26
    v_lshrrev_b32 v45, 16, v74
    s_mov_b32 exec_hi, 0x80000000
    v_mov_b32 v45, v44
    s_mov_b64 exec, -1
    v_mov_b32 v84, 0
    v_mov_b32 v85, 0
    v_mov_b32 v86, 0
    v_mov_b32 v87, 0
    v_lshlrev_b32 v88, 16, v40
    v_alignbit_b32 v89, v41, v40, 16
    s_mov_b64 s[20:21], exec
    s_mov_b64 exec, 3
    ds_write_b128 v37, v[84:87] offset:0
    ds_write_b128 v37, v[84:87] offset:4160
    ds_write_b128 v37, v[84:87] offset:8320
    ds_write_b128 v37, v[84:87] offset:12480
    s_mov_b64 exec, 1
    ds_write_b32 v37, v88 offset:4188
    ds_write_b32 v37, v40 offset:8348
    ds_write_b64 v37, v[88:89] offset:12504
    s_mov_b64 exec, s[20:21]
    ds_write_b128 v37, v[40:43] offset:32
    v_alignbit_b32 v92, v41, v40, 16
    v_alignbit_b32 v93, v42, v41, 16
    v_alignbit_b32 v94, v43, v42, 16
    v_alignbit_b32 v95, v44, v43, 16
    ds_write_b128 v37, v[92:95] offset:4192
    v_mov_b32 v100, v41
    v_mov_b32 v101, v42
    v_mov_b32 v102, v43
    v_mov_b32 v103, v44
    ds_write_b128 v37, v[100:103] offset:8352
    v_alignbit_b32 v96, v42, v41, 16
    v_alignbit_b32 v97, v43, v42, 16
    v_alignbit_b32 v98, v44, v43, 16
    v_alignbit_b32 v99, v45, v44, 16
    ds_write_b128 v37, v[96:99] offset:12512
    v_perm_b32 v48, v76, v76, s26
    v_mov_b32 v49, v76
    v_perm_b32 v50, v76, v76, s27
    v_perm_b32 v51, v77, v77, s26
    v_perm_b32 v52, v77, v77, s26
    v_perm_b32 v53, v77, v77, s26
    ds_write_b128 v37, v[48:51] offset:1056
    v_alignbit_b32 v104, v49, v48, 16
    v_alignbit_b32 v105, v50, v49, 16
    v_alignbit_b32 v106, v51, v50, 16
    v_alignbit_b32 v107, v52, v51, 16
    ds_write_b128 v37, v[104:107] offset:5216
    v_mov_b32 v112, v49
    v_mov_b32 v113, v50
    v_mov_b32 v114, v51
    v_mov_b32 v115, v52
    ds_write_b128 v37, v[112:115] offset:9376
    v_alignbit_b32 v108, v50, v49, 16
    v_alignbit_b32 v109, v51, v50, 16
    v_alignbit_b32 v110, v52, v51, 16
    v_alignbit_b32 v111, v53, v52, 16
    ds_write_b128 v37, v[108:111] offset:13536
    v_lshl_or_b32 v56, v78, 16, v78
    v_lshl_or_b32 v57, v78, 16, v78
    v_lshl_or_b32 v59, v79, 16, v79
    v_lshl_or_b32 v60, v79, 16, v79
    v_lshl_or_b32 v61, v79, 16, v79
    v_cndmask_b32 v78, v79, v78, vcc
    v_lshl_or_b32 v58, v79, 16, v78
    ds_write_b128 v37, v[56:59] offset:2080
    v_alignbit_b32 v92, v57, v56, 16
    v_alignbit_b32 v93, v58, v57, 16
    v_alignbit_b32 v94, v59, v58, 16
    v_alignbit_b32 v95, v60, v59, 16
    ds_write_b128 v37, v[92:95] offset:6240
    v_mov_b32 v100, v57
    v_mov_b32 v101, v58
    v_mov_b32 v102, v59
    v_mov_b32 v103, v60
    ds_write_b128 v37, v[100:103] offset:10400
    v_alignbit_b32 v96, v58, v57, 16
    v_alignbit_b32 v97, v59, v58, 16
    v_alignbit_b32 v98, v60, v59, 16
    v_alignbit_b32 v99, v61, v60, 16
    ds_write_b128 v37, v[96:99] offset:14560
    v_lshl_or_b32 v64, v80, 16, v80
    v_lshl_or_b32 v65, v80, 16, v80
    v_lshl_or_b32 v67, v81, 16, v81
    v_lshl_or_b32 v68, v81, 16, v81
    v_lshl_or_b32 v69, v81, 16, v81
    v_cndmask_b32 v80, v81, v80, vcc
    v_lshl_or_b32 v66, v81, 16, v80
    ds_write_b128 v37, v[64:67] offset:3104
    v_alignbit_b32 v104, v65, v64, 16
    v_alignbit_b32 v105, v66, v65, 16
    v_alignbit_b32 v106, v67, v66, 16
    v_alignbit_b32 v107, v68, v67, 16
    ds_write_b128 v37, v[104:107] offset:7264
    v_mov_b32 v112, v65
    v_mov_b32 v113, v66
    v_mov_b32 v114, v67
    v_mov_b32 v115, v68
    ds_write_b128 v37, v[112:115] offset:11424
    v_alignbit_b32 v108, v66, v65, 16
    v_alignbit_b32 v109, v67, v66, 16
    v_alignbit_b32 v110, v68, v67, 16
    v_alignbit_b32 v111, v69, v68, 16
    ds_write_b128 v37, v[108:111] offset:15584
L_conv:
    v_mov_b32 v8, 0
    v_mov_b32 v9, 0
    ds_write_b64 v4, v[8:9] offset:3072
    ds_read_b64 v[40:41], v2 offset:0
    ds_read_b64 v[42:43], v2 offset:8
    ds_read_b64 v[44:45], v2 offset:512
    ds_read_b64 v[46:47], v2 offset:520
    ds_read_b64 v[104:105], v2 offset:1024
    ds_read_b64 v[106:107], v2 offset:1032
    ds_read_b64 v[108:109], v2 offset:1536
    ds_read_b64 v[110:111], v2 offset:1544
    ds_read_b64 v[112:113], v2 offset:2048
    ds_read_b64 v[114:115], v2 offset:2056
    ds_read_b64 v[116:117], v2 offset:2560
    ds_read_b64 v[118:119], v2 offset:2568
    ds_read_b64 v[120:121], v2 offset:3072
    ds_read_b64 v[122:123], v2 offset:3080
    ds_read_b64 v[124:125], v2 offset:3584
    ds_read_b64 v[126:127], v2 offset:3592
    s_barrier
    ds_read_b128 v[152:155], v3 offset:2560
    ds_read_b128 v[156:159], v3 offset:2048
    s_waitcnt lgkmcnt(1)
    v_mfma_f32_16x16x32_bf16 v[8:11], v[40:43], v[152:155], 0
    ds_read_b128 v[160:163], v3 offset:2624
    ds_read_b128 v[164:167], v3 offset:2112
    s_waitcnt lgkmcnt(2)
    v_mfma_f32_16x16x32_bf16 v[12:15], v[40:43], v[156:159], 0
    ds_read_b64 v[48:49], v2 offset:64
    v_mfma_f32_16x16x32_bf16 v[12:15], v[44:47], v[152:155], v[12:15]
    ds_read_b64 v[50:51], v2 offset:72
    v_mfma_f32_16x16x32_bf16 v[16:19], v[44:47], v[156:159], 0
    ds_read_b64 v[52:53], v2 offset:576
    v_mfma_f32_16x16x32_bf16 v[16:19], v[104:107], v[152:155], v[16:19]
    ds_read_b64 v[54:55], v2 offset:584
    v_mfma_f32_16x16x32_bf16 v[20:23], v[104:107], v[156:159], 0
    ds_read_b64 v[128:129], v2 offset:1088
    ds_read_b64 v[130:131], v2 offset:1096
    v_mfma_f32_16x16x32_bf16 v[20:23], v[108:111], v[152:155], v[20:23]
    ds_read_b64 v[132:133], v2 offset:1600
    v_mfma_f32_16x16x32_bf16 v[24:27], v[108:111], v[156:159], 0
    ds_read_b64 v[134:135], v2 offset:1608
    v_mfma_f32_16x16x32_bf16 v[24:27], v[112:115], v[152:155], v[24:27]
    ds_read_b64 v[136:137], v2 offset:2112
    v_mfma_f32_16x16x32_bf16 v[28:31], v[112:115], v[156:159], 0
    ds_read_b64 v[138:139], v2 offset:2120
    v_mfma_f32_16x16x32_bf16 v[28:31], v[116:119], v[152:155], v[28:31]
    ds_read_b64 v[140:141], v2 offset:2624
    ds_read_b64 v[142:143], v2 offset:2632
    v_mfma_f32_16x16x32_bf16 v[32:35], v[116:119], v[156:159], 0
    ds_read_b64 v[144:145], v2 offset:3136
    v_mfma_f32_16x16x32_bf16 v[32:35], v[120:123], v[152:155], v[32:35]
    ds_read_b64 v[146:147], v2 offset:3144
    v_mfma_f32_16x16x32_bf16 v[36:39], v[120:123], v[156:159], 0
    ds_read_b64 v[148:149], v2 offset:3648
    v_mfma_f32_16x16x32_bf16 v[36:39], v[124:127], v[152:155], v[36:39]
    ds_read_b64 v[150:151], v2 offset:3656
    s_waitcnt lgkmcnt(14)
    v_mfma_f32_16x16x32_bf16 v[8:11], v[48:51], v[160:163], v[8:11]
    ds_read_b128 v[152:155], v3 offset:2688
    ds_read_b128 v[156:159], v3 offset:2176
    v_mfma_f32_16x16x32_bf16 v[12:15], v[48:51], v[164:167], v[12:15]
    ds_read_b64 v[56:57], v2 offset:128
    s_waitcnt lgkmcnt(15)
    v_mfma_f32_16x16x32_bf16 v[12:15], v[52:55], v[160:163], v[12:15]
    ds_read_b64 v[58:59], v2 offset:136
    v_mfma_f32_16x16x32_bf16 v[16:19], v[52:55], v[164:167], v[16:19]
    ds_read_b64 v[60:61], v2 offset:640
    s_waitcnt lgkmcnt(15)
    v_mfma_f32_16x16x32_bf16 v[16:19], v[128:131], v[160:163], v[16:19]
    ds_read_b64 v[62:63], v2 offset:648
    v_mfma_f32_16x16x32_bf16 v[20:23], v[128:131], v[164:167], v[20:23]
    ds_read_b64 v[104:105], v2 offset:1152
    ds_read_b64 v[106:107], v2 offset:1160
    s_waitcnt lgkmcnt(15)
    v_mfma_f32_16x16x32_bf16 v[20:23], v[132:135], v[160:163], v[20:23]
    ds_read_b64 v[108:109], v2 offset:1664
    v_mfma_f32_16x16x32_bf16 v[24:27], v[132:135], v[164:167], v[24:27]
    ds_read_b64 v[110:111], v2 offset:1672
    s_waitcnt lgkmcnt(15)
    v_mfma_f32_16x16x32_bf16 v[24:27], v[136:139], v[160:163], v[24:27]
    ds_read_b64 v[112:113], v2 offset:2176
    v_mfma_f32_16x16x32_bf16 v[28:31], v[136:139], v[164:167], v[28:31]
    ds_read_b64 v[114:115], v2 offset:2184
    s_waitcnt lgkmcnt(15)
    v_mfma_f32_16x16x32_bf16 v[28:31], v[140:143], v[160:163], v[28:31]
    ds_read_b64 v[116:117], v2 offset:2688
    ds_read_b64 v[118:119], v2 offset:2696
    v_mfma_f32_16x16x32_bf16 v[32:35], v[140:143], v[164:167], v[32:35]
    ds_read_b64 v[120:121], v2 offset:3200
    s_waitcnt lgkmcnt(15)
    v_mfma_f32_16x16x32_bf16 v[32:35], v[144:147], v[160:163], v[32:35]
    ds_read_b64 v[122:123], v2 offset:3208
    v_mfma_f32_16x16x32_bf16 v[36:39], v[144:147], v[164:167], v[36:39]
    ds_read_b64 v[124:125], v2 offset:3712
    v_mfma_f32_16x16x32_bf16 v[36:39], v[148:151], v[160:163], v[36:39]
    ds_read_b64 v[126:127], v2 offset:3720
    s_waitcnt lgkmcnt(14)
    v_mfma_f32_16x16x32_bf16 v[8:11], v[56:59], v[152:155], v[8:11]
    ds_read_b128 v[160:163], v3 offset:2752
    ds_read_b128 v[164:167], v3 offset:2240
    v_mfma_f32_16x16x32_bf16 v[12:15], v[56:59], v[156:159], v[12:15]
    ds_read_b64 v[64:65], v2 offset:192
    s_waitcnt lgkmcnt(15)
    v_mfma_f32_16x16x32_bf16 v[12:15], v[60:63], v[152:155], v[12:15]
    ds_read_b64 v[66:67], v2 offset:200
    v_mfma_f32_16x16x32_bf16 v[16:19], v[60:63], v[156:159], v[16:19]
    ds_read_b64 v[68:69], v2 offset:704
    s_waitcnt lgkmcnt(15)
    v_mfma_f32_16x16x32_bf16 v[16:19], v[104:107], v[152:155], v[16:19]
    ds_read_b64 v[70:71], v2 offset:712
    v_mfma_f32_16x16x32_bf16 v[20:23], v[104:107], v[156:159], v[20:23]
    ds_read_b64 v[128:129], v2 offset:1216
    ds_read_b64 v[130:131], v2 offset:1224
    s_waitcnt lgkmcnt(15)
    v_mfma_f32_16x16x32_bf16 v[20:23], v[108:111], v[152:155], v[20:23]
    ds_read_b64 v[132:133], v2 offset:1728
    v_mfma_f32_16x16x32_bf16 v[24:27], v[108:111], v[156:159], v[24:27]
    ds_read_b64 v[134:135], v2 offset:1736
    s_waitcnt lgkmcnt(15)
    v_mfma_f32_16x16x32_bf16 v[24:27], v[112:115], v[152:155], v[24:27]
    ds_read_b64 v[136:137], v2 offset:2240
    v_mfma_f32_16x16x32_bf16 v[28:31], v[112:115], v[156:159], v[28:31]
    ds_read_b64 v[138:139], v2 offset:2248
    s_waitcnt lgkmcnt(15)
    v_mfma_f32_16x16x32_bf16 v[28:31], v[116:119], v[152:155], v[28:31]
    ds_read_b64 v[140:141], v2 offset:2752
    ds_read_b64 v[142:143], v2 offset:2760
    v_mfma_f32_16x16x32_bf16 v[32:35], v[116:119], v[156:159], v[32:35]
    ds_read_b64 v[144:145], v2 offset:3264
    s_waitcnt lgkmcnt(15)
    v_mfma_f32_16x16x32_bf16 v[32:35], v[120:123], v[152:155], v[32:35]
    ds_read_b64 v[146:147], v2 offset:3272
    v_mfma_f32_16x16x32_bf16 v[36:39], v[120:123], v[156:159], v[36:39]
    ds_read_b64 v[148:149], v2 offset:3776
    v_mfma_f32_16x16x32_bf16 v[36:39], v[124:127], v[152:155], v[36:39]
    ds_read_b64 v[150:151], v2 offset:3784
    s_waitcnt lgkmcnt(14)
    v_mfma_f32_16x16x32_bf16 v[8:11], v[64:67], v[160:163], v[8:11]
    ds_read_b128 v[152:155], v3 offset:2816
    ds_read_b128 v[156:159], v3 offset:2304
    v_mfma_f32_16x16x32_bf16 v[12:15], v[64:67], v[164:167], v[12:15]
    ds_read_b64 v[72:73], v2 offset:256
    s_waitcnt lgkmcnt(15)
    v_mfma_f32_16x16x32_bf16 v[12:15], v[68:71], v[160:163], v[12:15]
    ds_read_b64 v[74:75], v2 offset:264
    v_mfma_f32_16x16x32_bf16 v[16:19], v[68:71], v[164:167], v[16:19]
    ds_read_b64 v[76:77], v2 offset:768
    s_waitcnt lgkmcnt(15)
    v_mfma_f32_16x16x32_bf16 v[16:19], v[128:131], v[160:163], v[16:19]
    ds_read_b64 v[78:79], v2 offset:776
    v_mfma_f32_16x16x32_bf16 v[20:23], v[128:131], v[164:167], v[20:23]
    ds_read_b64 v[104:105], v2 offset:1280
    ds_read_b64 v[106:107], v2 offset:1288
    s_waitcnt lgkmcnt(15)
    v_mfma_f32_16x16x32_bf16 v[20:23], v[132:135], v[160:163], v[20:23]
    ds_read_b64 v[108:109], v2 offset:1792
    v_mfma_f32_16x16x32_bf16 v[24:27], v[132:135], v[164:167], v[24:27]
    ds_read_b64 v[110:111], v2 offset:1800
    s_waitcnt lgkmcnt(15)
    v_mfma_f32_16x16x32_bf16 v[24:27], v[136:139], v[160:163], v[24:27]
    ds_read_b64 v[112:113], v2 offset:2304
    v_mfma_f32_16x16x32_bf16 v[28:31], v[136:139], v[164:167], v[28:31]
    ds_read_b64 v[114:115], v2 offset:2312
    s_waitcnt lgkmcnt(15)
    v_mfma_f32_16x16x32_bf16 v[28:31], v[140:143], v[160:163], v[28:31]
    ds_read_b64 v[116:117], v2 offset:2816
    ds_read_b64 v[118:119], v2 offset:2824
    v_mfma_f32_16x16x32_bf16 v[32:35], v[140:143], v[164:167], v[32:35]
    ds_read_b64 v[120:121], v2 offset:3328
    s_waitcnt lgkmcnt(15)
    v_mfma_f32_16x16x32_bf16 v[32:35], v[144:147], v[160:163], v[32:35]
    ds_read_b64 v[122:123], v2 offset:3336
    v_mfma_f32_16x16x32_bf16 v[36:39], v[144:147], v[164:167], v[36:39]
    ds_read_b64 v[124:125], v2 offset:3840
    v_mfma_f32_16x16x32_bf16 v[36:39], v[148:151], v[160:163], v[36:39]
    ds_read_b64 v[126:127], v2 offset:3848
    s_waitcnt lgkmcnt(14)
    v_mfma_f32_16x16x32_bf16 v[8:11], v[72:75], v[152:155], v[8:11]
    ds_read_b128 v[160:163], v3 offset:2880
    ds_read_b128 v[164:167], v3 offset:2368
    v_mfma_f32_16x16x32_bf16 v[12:15], v[72:75], v[156:159], v[12:15]
    ds_read_b64 v[80:81], v2 offset:320
    s_waitcnt lgkmcnt(15)
    v_mfma_f32_16x16x32_bf16 v[12:15], v[76:79], v[152:155], v[12:15]
    ds_read_b64 v[82:83], v2 offset:328
    v_mfma_f32_16x16x32_bf16 v[16:19], v[76:79], v[156:159], v[16:19]
    ds_read_b64 v[84:85], v2 offset:832
    s_waitcnt lgkmcnt(15)
    v_mfma_f32_16x16x32_bf16 v[16:19], v[104:107], v[152:155], v[16:19]
    ds_read_b64 v[86:87], v2 offset:840
    v_mfma_f32_16x16x32_bf16 v[20:23], v[104:107], v[156:159], v[20:23]
    ds_read_b64 v[128:129], v2 offset:1344
    ds_read_b64 v[130:131], v2 offset:1352
    s_waitcnt lgkmcnt(15)
    v_mfma_f32_16x16x32_bf16 v[20:23], v[108:111], v[152:155], v[20:23]
    ds_read_b64 v[132:133], v2 offset:1856
    v_mfma_f32_16x16x32_bf16 v[24:27], v[108:111], v[156:159], v[24:27]
    ds_read_b64 v[134:135], v2 offset:1864
    s_waitcnt lgkmcnt(15)
    v_mfma_f32_16x16x32_bf16 v[24:27], v[112:115], v[152:155], v[24:27]
    ds_read_b64 v[136:137], v2 offset:2368
    v_mfma_f32_16x16x32_bf16 v[28:31], v[112:115], v[156:159], v[28:31]
    ds_read_b64 v[138:139], v2 offset:2376
    s_waitcnt lgkmcnt(15)
    v_mfma_f32_16x16x32_bf16 v[28:31], v[116:119], v[152:155], v[28:31]
    ds_read_b64 v[140:141], v2 offset:2880
    ds_read_b64 v[142:143], v2 offset:2888
    v_mfma_f32_16x16x32_bf16 v[32:35], v[116:119], v[156:159], v[32:35]
    ds_read_b64 v[144:145], v2 offset:3392
    s_waitcnt lgkmcnt(15)
    v_mfma_f32_16x16x32_bf16 v[32:35], v[120:123], v[152:155], v[32:35]
    ds_read_b64 v[146:147], v2 offset:3400
    v_mfma_f32_16x16x32_bf16 v[36:39], v[120:123], v[156:159], v[36:39]
    ds_read_b64 v[148:149], v2 offset:3904
    v_mfma_f32_16x16x32_bf16 v[36:39], v[124:127], v[152:155], v[36:39]
    ds_read_b64 v[150:151], v2 offset:3912
    s_waitcnt lgkmcnt(14)
    v_mfma_f32_16x16x32_bf16 v[8:11], v[80:83], v[160:163], v[8:11]
    ds_read_b128 v[152:155], v3 offset:2944
    ds_read_b128 v[156:159], v3 offset:2432
    v_mfma_f32_16x16x32_bf16 v[12:15], v[80:83], v[164:167], v[12:15]
    ds_read_b64 v[88:89], v2 offset:384
    s_waitcnt lgkmcnt(15)
    v_mfma_f32_16x16x32_bf16 v[12:15], v[84:87], v[160:163], v[12:15]
    ds_read_b64 v[90:91], v2 offset:392
    v_mfma_f32_16x16x32_bf16 v[16:19], v[84:87], v[164:167], v[16:19]
    ds_read_b64 v[92:93], v2 offset:896
    s_waitcnt lgkmcnt(15)
    v_mfma_f32_16x16x32_bf16 v[16:19], v[128:131], v[160:163], v[16:19]
    ds_read_b64 v[94:95], v2 offset:904
    v_mfma_f32_16x16x32_bf16 v[20:23], v[128:131], v[164:167], v[20:23]
    ds_read_b64 v[104:105], v2 offset:1408
    ds_read_b64 v[106:107], v2 offset:1416
    s_waitcnt lgkmcnt(15)
    v_mfma_f32_16x16x32_bf16 v[20:23], v[132:135], v[160:163], v[20:23]
    ds_read_b64 v[108:109], v2 offset:1920
    v_mfma_f32_16x16x32_bf16 v[24:27], v[132:135], v[164:167], v[24:27]
    ds_read_b64 v[110:111], v2 offset:1928
    s_waitcnt lgkmcnt(15)
    v_mfma_f32_16x16x32_bf16 v[24:27], v[136:139], v[160:163], v[24:27]
    ds_read_b64 v[112:113], v2 offset:2432
    v_mfma_f32_16x16x32_bf16 v[28:31], v[136:139], v[164:167], v[28:31]
    ds_read_b64 v[114:115], v2 offset:2440
    s_waitcnt lgkmcnt(15)
    v_mfma_f32_16x16x32_bf16 v[28:31], v[140:143], v[160:163], v[28:31]
    ds_read_b64 v[116:117], v2 offset:2944
    ds_read_b64 v[118:119], v2 offset:2952
    v_mfma_f32_16x16x32_bf16 v[32:35], v[140:143], v[164:167], v[32:35]
    ds_read_b64 v[120:121], v2 offset:3456
    s_waitcnt lgkmcnt(15)
    v_mfma_f32_16x16x32_bf16 v[32:35], v[144:147], v[160:163], v[32:35]
    ds_read_b64 v[122:123], v2 offset:3464
    v_mfma_f32_16x16x32_bf16 v[36:39], v[144:147], v[164:167], v[36:39]
    ds_read_b64 v[124:125], v2 offset:3968
    v_mfma_f32_16x16x32_bf16 v[36:39], v[148:151], v[160:163], v[36:39]
    ds_read_b64 v[126:127], v2 offset:3976
    s_waitcnt lgkmcnt(14)
    v_mfma_f32_16x16x32_bf16 v[8:11], v[88:91], v[152:155], v[8:11]
    ds_read_b128 v[160:163], v3 offset:3008
    ds_read_b128 v[164:167], v3 offset:2496
    v_mfma_f32_16x16x32_bf16 v[12:15], v[88:91], v[156:159], v[12:15]
    ds_read_b64 v[96:97], v2 offset:448
    s_waitcnt lgkmcnt(15)
    v_mfma_f32_16x16x32_bf16 v[12:15], v[92:95], v[152:155], v[12:15]
    ds_read_b64 v[98:99], v2 offset:456
    v_mfma_f32_16x16x32_bf16 v[16:19], v[92:95], v[156:159], v[16:19]
    ds_read_b64 v[100:101], v2 offset:960
    s_waitcnt lgkmcnt(15)
    v_mfma_f32_16x16x32_bf16 v[16:19], v[104:107], v[152:155], v[16:19]
    ds_read_b64 v[102:103], v2 offset:968
    v_mfma_f32_16x16x32_bf16 v[20:23], v[104:107], v[156:159], v[20:23]
    ds_read_b64 v[128:129], v2 offset:1472
    ds_read_b64 v[130:131], v2 offset:1480
    s_waitcnt lgkmcnt(15)
    v_mfma_f32_16x16x32_bf16 v[20:23], v[108:111], v[152:155], v[20:23]
    ds_read_b64 v[132:133], v2 offset:1984
    v_mfma_f32_16x16x32_bf16 v[24:27], v[108:111], v[156:159], v[24:27]
    ds_read_b64 v[134:135], v2 offset:1992
    s_waitcnt lgkmcnt(15)
    v_mfma_f32_16x16x32_bf16 v[24:27], v[112:115], v[152:155], v[24:27]
    ds_read_b64 v[136:137], v2 offset:2496
    v_mfma_f32_16x16x32_bf16 v[28:31], v[112:115], v[156:159], v[28:31]
    ds_read_b64 v[138:139], v2 offset:2504
    s_waitcnt lgkmcnt(15)
    v_mfma_f32_16x16x32_bf16 v[28:31], v[116:119], v[152:155], v[28:31]
    ds_read_b64 v[140:141], v2 offset:3008
    ds_read_b64 v[142:143], v2 offset:3016
    v_mfma_f32_16x16x32_bf16 v[32:35], v[116:119], v[156:159], v[32:35]
    ds_read_b64 v[144:145], v2 offset:3520
    s_waitcnt lgkmcnt(15)
    v_mfma_f32_16x16x32_bf16 v[32:35], v[120:123], v[152:155], v[32:35]
    ds_read_b64 v[146:147], v2 offset:3528
    v_mfma_f32_16x16x32_bf16 v[36:39], v[120:123], v[156:159], v[36:39]
    ds_read_b64 v[148:149], v2 offset:4032
    v_mfma_f32_16x16x32_bf16 v[36:39], v[124:127], v[152:155], v[36:39]
    ds_read_b64 v[150:151], v2 offset:4040
    s_waitcnt lgkmcnt(14)
    v_mfma_f32_16x16x32_bf16 v[8:11], v[96:99], v[160:163], v[8:11]
    ds_read_b64 v[104:105], v2 offset:1024
    v_mfma_f32_16x16x32_bf16 v[12:15], v[96:99], v[164:167], v[12:15]
    ds_read_b64 v[106:107], v2 offset:1032
    s_waitcnt lgkmcnt(14)
    v_mfma_f32_16x16x32_bf16 v[12:15], v[100:103], v[160:163], v[12:15]
    ds_read_b64 v[108:109], v2 offset:1536
    v_mfma_f32_16x16x32_bf16 v[16:19], v[100:103], v[164:167], v[16:19]
    ds_read_b64 v[110:111], v2 offset:1544
    s_waitcnt lgkmcnt(14)
    v_mfma_f32_16x16x32_bf16 v[16:19], v[128:131], v[160:163], v[16:19]
    ds_read_b64 v[112:113], v2 offset:2048
    v_mfma_f32_16x16x32_bf16 v[20:23], v[128:131], v[164:167], v[20:23]
    ds_read_b64 v[114:115], v2 offset:2056
    s_waitcnt lgkmcnt(14)
    v_mfma_f32_16x16x32_bf16 v[20:23], v[132:135], v[160:163], v[20:23]
    ds_read_b64 v[116:117], v2 offset:2560
    s_nop 3
    v_cvt_pk_bf16_f32 v8, v8, v9
    v_cvt_pk_bf16_f32 v9, v10, v11
    ds_write_b64 v5, v[8:9] offset:0
    v_cvt_pk_bf16_f32 v12, v12, v13
    v_cvt_pk_bf16_f32 v13, v14, v15
    ds_write_b64 v5, v[12:13] offset:512
    v_mfma_f32_16x16x32_bf16 v[24:27], v[132:135], v[164:167], v[24:27]
    ds_read_b64 v[118:119], v2 offset:2568
    s_waitcnt lgkmcnt(15)
    v_mfma_f32_16x16x32_bf16 v[24:27], v[136:139], v[160:163], v[24:27]
    v_mfma_f32_16x16x32_bf16 v[28:31], v[136:139], v[164:167], v[28:31]
    s_waitcnt lgkmcnt(14)
    v_mfma_f32_16x16x32_bf16 v[28:31], v[140:143], v[160:163], v[28:31]
    v_mfma_f32_16x16x32_bf16 v[32:35], v[140:143], v[164:167], v[32:35]
    s_waitcnt lgkmcnt(12)
    v_mfma_f32_16x16x32_bf16 v[32:35], v[144:147], v[160:163], v[32:35]
    v_mfma_f32_16x16x32_bf16 v[36:39], v[144:147], v[164:167], v[36:39]
    s_waitcnt lgkmcnt(10)
    v_mfma_f32_16x16x32_bf16 v[36:39], v[148:151], v[160:163], v[36:39]
    s_waitcnt lgkmcnt(1)
    s_barrier
    ds_read_b128 v[152:155], v3 offset:1536
    ds_read_b128 v[156:159], v3 offset:1024
    s_waitcnt lgkmcnt(1)
    v_mfma_f32_16x16x32_bf16 v[16:19], v[40:43], v[152:155], v[16:19]
    ds_read_b128 v[160:163], v3 offset:1600
    s_waitcnt lgkmcnt(1)
    v_mfma_f32_16x16x32_bf16 v[20:23], v[40:43], v[156:159], v[20:23]
    ds_read_b128 v[164:167], v3 offset:1088
    v_mfma_f32_16x16x32_bf16 v[20:23], v[44:47], v[152:155], v[20:23]
    ds_read_b64 v[128:129], v2 offset:1088
    v_mfma_f32_16x16x32_bf16 v[24:27], v[44:47], v[156:159], v[24:27]
    ds_read_b64 v[130:131], v2 offset:1096
    v_mfma_f32_16x16x32_bf16 v[24:27], v[104:107], v[152:155], v[24:27]
    ds_read_b64 v[132:133], v2 offset:1600
    v_mfma_f32_16x16x32_bf16 v[28:31], v[104:107], v[156:159], v[28:31]
    ds_read_b64 v[134:135], v2 offset:1608
    v_mfma_f32_16x16x32_bf16 v[28:31], v[108:111], v[152:155], v[28:31]
    ds_read_b64 v[136:137], v2 offset:2112
    v_mfma_f32_16x16x32_bf16 v[32:35], v[108:111], v[156:159], v[32:35]
    ds_read_b64 v[138:139], v2 offset:2120
    v_mfma_f32_16x16x32_bf16 v[32:35], v[112:115], v[152:155], v[32:35]
    ds_read_b64 v[140:141], v2 offset:2624
    v_mfma_f32_16x16x32_bf16 v[36:39], v[112:115], v[156:159], v[36:39]
    ds_read_b64 v[142:143], v2 offset:2632
    v_mfma_f32_16x16x32_bf16 v[36:39], v[116:119], v[152:155], v[36:39]
    s_waitcnt lgkmcnt(9)
    v_mfma_f32_16x16x32_bf16 v[16:19], v[48:51], v[160:163], v[16:19]
    ds_read_b128 v[152:155], v3 offset:1664
    s_waitcnt lgkmcnt(9)
    v_mfma_f32_16x16x32_bf16 v[20:23], v[48:51], v[164:167], v[20:23]
    ds_read_b128 v[156:159], v3 offset:1152
    v_mfma_f32_16x16x32_bf16 v[20:23], v[52:55], v[160:163], v[20:23]
    ds_read_b64 v[104:105], v2 offset:1152
    v_mfma_f32_16x16x32_bf16 v[24:27], v[52:55], v[164:167], v[24:27]
    ds_read_b64 v[106:107], v2 offset:1160
    s_waitcnt lgkmcnt(10)
    v_mfma_f32_16x16x32_bf16 v[24:27], v[128:131], v[160:163], v[24:27]
    ds_read_b64 v[108:109], v2 offset:1664
    v_mfma_f32_16x16x32_bf16 v[28:31], v[128:131], v[164:167], v[28:31]
    ds_read_b64 v[110:111], v2 offset:1672
    s_waitcnt lgkmcnt(10)
    v_mfma_f32_16x16x32_bf16 v[28:31], v[132:135], v[160:163], v[28:31]
    ds_read_b64 v[112:113], v2 offset:2176
    v_mfma_f32_16x16x32_bf16 v[32:35], v[132:135], v[164:167], v[32:35]
    ds_read_b64 v[114:115], v2 offset:2184
    s_waitcnt lgkmcnt(10)
    v_mfma_f32_16x16x32_bf16 v[32:35], v[136:139], v[160:163], v[32:35]
    ds_read_b64 v[116:117], v2 offset:2688
    v_mfma_f32_16x16x32_bf16 v[36:39], v[136:139], v[164:167], v[36:39]
    ds_read_b64 v[118:119], v2 offset:2696
    s_waitcnt lgkmcnt(10)
    v_mfma_f32_16x16x32_bf16 v[36:39], v[140:143], v[160:163], v[36:39]
    s_waitcnt lgkmcnt(9)
    v_mfma_f32_16x16x32_bf16 v[16:19], v[56:59], v[152:155], v[16:19]
    ds_read_b128 v[160:163], v3 offset:1728
    s_waitcnt lgkmcnt(9)
    v_mfma_f32_16x16x32_bf16 v[20:23], v[56:59], v[156:159], v[20:23]
    ds_read_b128 v[164:167], v3 offset:1216
    v_mfma_f32_16x16x32_bf16 v[20:23], v[60:63], v[152:155], v[20:23]
    ds_read_b64 v[128:129], v2 offset:1216
    v_mfma_f32_16x16x32_bf16 v[24:27], v[60:63], v[156:159], v[24:27]
    ds_read_b64 v[130:131], v2 offset:1224
    s_waitcnt lgkmcnt(10)
    v_mfma_f32_16x16x32_bf16 v[24:27], v[104:107], v[152:155], v[24:27]
    ds_read_b64 v[132:133], v2 offset:1728
    v_mfma_f32_16x16x32_bf16 v[28:31], v[104:107], v[156:159], v[28:31]
    ds_read_b64 v[134:135], v2 offset:1736
    s_waitcnt lgkmcnt(10)
    v_mfma_f32_16x16x32_bf16 v[28:31], v[108:111], v[152:155], v[28:31]
    ds_read_b64 v[136:137], v2 offset:2240
    v_mfma_f32_16x16x32_bf16 v[32:35], v[108:111], v[156:159], v[32:35]
    ds_read_b64 v[138:139], v2 offset:2248
    s_waitcnt lgkmcnt(10)
    v_mfma_f32_16x16x32_bf16 v[32:35], v[112:115], v[152:155], v[32:35]
    ds_read_b64 v[140:141], v2 offset:2752
    v_mfma_f32_16x16x32_bf16 v[36:39], v[112:115], v[156:159], v[36:39]
    ds_read_b64 v[142:143], v2 offset:2760
    s_waitcnt lgkmcnt(10)
    v_mfma_f32_16x16x32_bf16 v[36:39], v[116:119], v[152:155], v[36:39]
    s_waitcnt lgkmcnt(9)
    v_mfma_f32_16x16x32_bf16 v[16:19], v[64:67], v[160:163], v[16:19]
    ds_read_b128 v[152:155], v3 offset:1792
    s_waitcnt lgkmcnt(9)
    v_mfma_f32_16x16x32_bf16 v[20:23], v[64:67], v[164:167], v[20:23]
    ds_read_b128 v[156:159], v3 offset:1280
    v_mfma_f32_16x16x32_bf16 v[20:23], v[68:71], v[160:163], v[20:23]
    ds_read_b64 v[104:105], v2 offset:1280
    v_mfma_f32_16x16x32_bf16 v[24:27], v[68:71], v[164:167], v[24:27]
    ds_read_b64 v[106:107], v2 offset:1288
    s_waitcnt lgkmcnt(10)
    v_mfma_f32_16x16x32_bf16 v[24:27], v[128:131], v[160:163], v[24:27]
    ds_read_b64 v[108:109], v2 offset:1792
    v_mfma_f32_16x16x32_bf16 v[28:31], v[128:131], v[164:167], v[28:31]
    ds_read_b64 v[110:111], v2 offset:1800
    s_waitcnt lgkmcnt(10)
    v_mfma_f32_16x16x32_bf16 v[28:31], v[132:135], v[160:163], v[28:31]
    ds_read_b64 v[112:113], v2 offset:2304
    v_mfma_f32_16x16x32_bf16 v[32:35], v[132:135], v[164:167], v[32:35]
    ds_read_b64 v[114:115], v2 offset:2312
    s_waitcnt lgkmcnt(10)
    v_mfma_f32_16x16x32_bf16 v[32:35], v[136:139], v[160:163], v[32:35]
    ds_read_b64 v[116:117], v2 offset:2816
    v_mfma_f32_16x16x32_bf16 v[36:39], v[136:139], v[164:167], v[36:39]
    ds_read_b64 v[118:119], v2 offset:2824
    s_waitcnt lgkmcnt(10)
    v_mfma_f32_16x16x32_bf16 v[36:39], v[140:143], v[160:163], v[36:39]
    s_waitcnt lgkmcnt(9)
    v_mfma_f32_16x16x32_bf16 v[16:19], v[72:75], v[152:155], v[16:19]
    ds_read_b128 v[160:163], v3 offset:1856
    s_waitcnt lgkmcnt(9)
    v_mfma_f32_16x16x32_bf16 v[20:23], v[72:75], v[156:159], v[20:23]
    ds_read_b128 v[164:167], v3 offset:1344
    v_mfma_f32_16x16x32_bf16 v[20:23], v[76:79], v[152:155], v[20:23]
    ds_read_b64 v[128:129], v2 offset:1344
    v_mfma_f32_16x16x32_bf16 v[24:27], v[76:79], v[156:159], v[24:27]
    ds_read_b64 v[130:131], v2 offset:1352
    s_waitcnt lgkmcnt(10)
    v_mfma_f32_16x16x32_bf16 v[24:27], v[104:107], v[152:155], v[24:27]
    ds_read_b64 v[132:133], v2 offset:1856
    v_mfma_f32_16x16x32_bf16 v[28:31], v[104:107], v[156:159], v[28:31]
    ds_read_b64 v[134:135], v2 offset:1864
    s_waitcnt lgkmcnt(10)
    v_mfma_f32_16x16x32_bf16 v[28:31], v[108:111], v[152:155], v[28:31]
    ds_read_b64 v[136:137], v2 offset:2368
    v_mfma_f32_16x16x32_bf16 v[32:35], v[108:111], v[156:159], v[32:35]
    ds_read_b64 v[138:139], v2 offset:2376
    s_waitcnt lgkmcnt(10)
    v_mfma_f32_16x16x32_bf16 v[32:35], v[112:115], v[152:155], v[32:35]
    ds_read_b64 v[140:141], v2 offset:2880
    v_mfma_f32_16x16x32_bf16 v[36:39], v[112:115], v[156:159], v[36:39]
    ds_read_b64 v[142:143], v2 offset:2888
    s_waitcnt lgkmcnt(10)
    v_mfma_f32_16x16x32_bf16 v[36:39], v[116:119], v[152:155], v[36:39]
    s_waitcnt lgkmcnt(9)
    v_mfma_f32_16x16x32_bf16 v[16:19], v[80:83], v[160:163], v[16:19]
    ds_read_b128 v[152:155], v3 offset:1920
    s_waitcnt lgkmcnt(9)
    v_mfma_f32_16x16x32_bf16 v[20:23], v[80:83], v[164:167], v[20:23]
    ds_read_b128 v[156:159], v3 offset:1408
    v_mfma_f32_16x16x32_bf16 v[20:23], v[84:87], v[160:163], v[20:23]
    ds_read_b64 v[104:105], v2 offset:1408
    v_mfma_f32_16x16x32_bf16 v[24:27], v[84:87], v[164:167], v[24:27]
    ds_read_b64 v[106:107], v2 offset:1416
    s_waitcnt lgkmcnt(10)
    v_mfma_f32_16x16x32_bf16 v[24:27], v[128:131], v[160:163], v[24:27]
    ds_read_b64 v[108:109], v2 offset:1920
    v_mfma_f32_16x16x32_bf16 v[28:31], v[128:131], v[164:167], v[28:31]
    ds_read_b64 v[110:111], v2 offset:1928
    s_waitcnt lgkmcnt(10)
    v_mfma_f32_16x16x32_bf16 v[28:31], v[132:135], v[160:163], v[28:31]
    ds_read_b64 v[112:113], v2 offset:2432
    v_mfma_f32_16x16x32_bf16 v[32:35], v[132:135], v[164:167], v[32:35]
    ds_read_b64 v[114:115], v2 offset:2440
    s_waitcnt lgkmcnt(10)
    v_mfma_f32_16x16x32_bf16 v[32:35], v[136:139], v[160:163], v[32:35]
    ds_read_b64 v[116:117], v2 offset:2944
    v_mfma_f32_16x16x32_bf16 v[36:39], v[136:139], v[164:167], v[36:39]
    ds_read_b64 v[118:119], v2 offset:2952
    s_waitcnt lgkmcnt(10)
    v_mfma_f32_16x16x32_bf16 v[36:39], v[140:143], v[160:163], v[36:39]
    s_waitcnt lgkmcnt(9)
    v_mfma_f32_16x16x32_bf16 v[16:19], v[88:91], v[152:155], v[16:19]
    ds_read_b128 v[160:163], v3 offset:1984
    s_waitcnt lgkmcnt(9)
    v_mfma_f32_16x16x32_bf16 v[20:23], v[88:91], v[156:159], v[20:23]
    ds_read_b128 v[164:167], v3 offset:1472
    v_mfma_f32_16x16x32_bf16 v[20:23], v[92:95], v[152:155], v[20:23]
    ds_read_b64 v[128:129], v2 offset:1472
    v_mfma_f32_16x16x32_bf16 v[24:27], v[92:95], v[156:159], v[24:27]
    ds_read_b64 v[130:131], v2 offset:1480
    s_waitcnt lgkmcnt(10)
    v_mfma_f32_16x16x32_bf16 v[24:27], v[104:107], v[152:155], v[24:27]
    ds_read_b64 v[132:133], v2 offset:1984
    v_mfma_f32_16x16x32_bf16 v[28:31], v[104:107], v[156:159], v[28:31]
    ds_read_b64 v[134:135], v2 offset:1992
    s_waitcnt lgkmcnt(10)
    v_mfma_f32_16x16x32_bf16 v[28:31], v[108:111], v[152:155], v[28:31]
    ds_read_b64 v[136:137], v2 offset:2496
    v_mfma_f32_16x16x32_bf16 v[32:35], v[108:111], v[156:159], v[32:35]
    ds_read_b64 v[138:139], v2 offset:2504
    s_waitcnt lgkmcnt(10)
    v_mfma_f32_16x16x32_bf16 v[32:35], v[112:115], v[152:155], v[32:35]
    ds_read_b64 v[140:141], v2 offset:3008
    v_mfma_f32_16x16x32_bf16 v[36:39], v[112:115], v[156:159], v[36:39]
    ds_read_b64 v[142:143], v2 offset:3016
    s_waitcnt lgkmcnt(10)
    v_mfma_f32_16x16x32_bf16 v[36:39], v[116:119], v[152:155], v[36:39]
    s_waitcnt lgkmcnt(9)
    v_mfma_f32_16x16x32_bf16 v[16:19], v[96:99], v[160:163], v[16:19]
    ds_read_b64 v[104:105], v2 offset:1024
    s_waitcnt lgkmcnt(9)
    v_mfma_f32_16x16x32_bf16 v[20:23], v[96:99], v[164:167], v[20:23]
    ds_read_b64 v[106:107], v2 offset:1032
    v_mfma_f32_16x16x32_bf16 v[20:23], v[100:103], v[160:163], v[20:23]
    ds_read_b64 v[108:109], v2 offset:1536
    v_mfma_f32_16x16x32_bf16 v[24:27], v[100:103], v[164:167], v[24:27]
    ds_read_b64 v[110:111], v2 offset:1544
    s_waitcnt lgkmcnt(10)
    v_mfma_f32_16x16x32_bf16 v[24:27], v[128:131], v[160:163], v[24:27]
    v_mfma_f32_16x16x32_bf16 v[28:31], v[128:131], v[164:167], v[28:31]
    s_waitcnt lgkmcnt(8)
    v_mfma_f32_16x16x32_bf16 v[28:31], v[132:135], v[160:163], v[28:31]
    s_nop 3
    v_cvt_pk_bf16_f32 v16, v16, v17
    v_cvt_pk_bf16_f32 v17, v18, v19
    ds_write_b64 v5, v[16:17] offset:4160
    v_cvt_pk_bf16_f32 v20, v20, v21
    v_cvt_pk_bf16_f32 v21, v22, v23
    ds_write_b64 v5, v[20:21] offset:4672
    v_mfma_f32_16x16x32_bf16 v[32:35], v[132:135], v[164:167], v[32:35]
    s_waitcnt lgkmcnt(8)
    v_mfma_f32_16x16x32_bf16 v[32:35], v[136:139], v[160:163], v[32:35]
    v_mfma_f32_16x16x32_bf16 v[36:39], v[136:139], v[164:167], v[36:39]
    s_waitcnt lgkmcnt(6)
    v_mfma_f32_16x16x32_bf16 v[36:39], v[140:143], v[160:163], v[36:39]
    s_waitcnt lgkmcnt(0)
    s_barrier
    ds_read_b128 v[152:155], v3 offset:512
    ds_read_b128 v[156:159], v3 offset:0
    s_waitcnt lgkmcnt(1)
    v_mfma_f32_16x16x32_bf16 v[24:27], v[40:43], v[152:155], v[24:27]
    ds_read_b128 v[160:163], v3 offset:576
    s_waitcnt lgkmcnt(1)
    v_mfma_f32_16x16x32_bf16 v[28:31], v[40:43], v[156:159], v[28:31]
    ds_read_b128 v[164:167], v3 offset:64
    v_mfma_f32_16x16x32_bf16 v[28:31], v[44:47], v[152:155], v[28:31]
    ds_read_b64 v[128:129], v2 offset:1088
    v_mfma_f32_16x16x32_bf16 v[32:35], v[44:47], v[156:159], v[32:35]
    ds_read_b64 v[130:131], v2 offset:1096
    v_mfma_f32_16x16x32_bf16 v[32:35], v[104:107], v[152:155], v[32:35]
    ds_read_b64 v[132:133], v2 offset:1600
    v_mfma_f32_16x16x32_bf16 v[36:39], v[104:107], v[156:159], v[36:39]
    ds_read_b64 v[134:135], v2 offset:1608
    v_mfma_f32_16x16x32_bf16 v[36:39], v[108:111], v[152:155], v[36:39]
    s_waitcnt lgkmcnt(5)
    v_mfma_f32_16x16x32_bf16 v[24:27], v[48:51], v[160:163], v[24:27]
    ds_read_b128 v[152:155], v3 offset:640
    s_waitcnt lgkmcnt(5)
    v_mfma_f32_16x16x32_bf16 v[28:31], v[48:51], v[164:167], v[28:31]
    ds_read_b128 v[156:159], v3 offset:128
    v_mfma_f32_16x16x32_bf16 v[28:31], v[52:55], v[160:163], v[28:31]
    ds_read_b64 v[104:105], v2 offset:1152
    v_mfma_f32_16x16x32_bf16 v[32:35], v[52:55], v[164:167], v[32:35]
    ds_read_b64 v[106:107], v2 offset:1160
    s_waitcnt lgkmcnt(6)
    v_mfma_f32_16x16x32_bf16 v[32:35], v[128:131], v[160:163], v[32:35]
    ds_read_b64 v[108:109], v2 offset:1664
    v_mfma_f32_16x16x32_bf16 v[36:39], v[128:131], v[164:167], v[36:39]
    ds_read_b64 v[110:111], v2 offset:1672
    s_waitcnt lgkmcnt(6)
    v_mfma_f32_16x16x32_bf16 v[36:39], v[132:135], v[160:163], v[36:39]
    s_waitcnt lgkmcnt(5)
    v_mfma_f32_16x16x32_bf16 v[24:27], v[56:59], v[152:155], v[24:27]
    ds_read_b128 v[160:163], v3 offset:704
    s_waitcnt lgkmcnt(5)
    v_mfma_f32_16x16x32_bf16 v[28:31], v[56:59], v[156:159], v[28:31]
    ds_read_b128 v[164:167], v3 offset:192
    v_mfma_f32_16x16x32_bf16 v[28:31], v[60:63], v[152:155], v[28:31]
    ds_read_b64 v[128:129], v2 offset:1216
    v_mfma_f32_16x16x32_bf16 v[32:35], v[60:63], v[156:159], v[32:35]
    ds_read_b64 v[130:131], v2 offset:1224
    s_waitcnt lgkmcnt(6)
    v_mfma_f32_16x16x32_bf16 v[32:35], v[104:107], v[152:155], v[32:35]
    ds_read_b64 v[132:133], v2 offset:1728
    v_mfma_f32_16x16x32_bf16 v[36:39], v[104:107], v[156:159], v[36:39]
    ds_read_b64 v[134:135], v2 offset:1736
    s_waitcnt lgkmcnt(6)
    v_mfma_f32_16x16x32_bf16 v[36:39], v[108:111], v[152:155], v[36:39]
    s_waitcnt lgkmcnt(5)
    v_mfma_f32_16x16x32_bf16 v[24:27], v[64:67], v[160:163], v[24:27]
    ds_read_b128 v[152:155], v3 offset:768
    s_waitcnt lgkmcnt(5)
    v_mfma_f32_16x16x32_bf16 v[28:31], v[64:67], v[164:167], v[28:31]
    ds_read_b128 v[156:159], v3 offset:256
    v_mfma_f32_16x16x32_bf16 v[28:31], v[68:71], v[160:163], v[28:31]
    ds_read_b64 v[104:105], v2 offset:1280
    v_mfma_f32_16x16x32_bf16 v[32:35], v[68:71], v[164:167], v[32:35]
    ds_read_b64 v[106:107], v2 offset:1288
    s_waitcnt lgkmcnt(6)
    v_mfma_f32_16x16x32_bf16 v[32:35], v[128:131], v[160:163], v[32:35]
    ds_read_b64 v[108:109], v2 offset:1792
    v_mfma_f32_16x16x32_bf16 v[36:39], v[128:131], v[164:167], v[36:39]
    ds_read_b64 v[110:111], v2 offset:1800
    s_waitcnt lgkmcnt(6)
    v_mfma_f32_16x16x32_bf16 v[36:39], v[132:135], v[160:163], v[36:39]
    s_waitcnt lgkmcnt(5)
    v_mfma_f32_16x16x32_bf16 v[24:27], v[72:75], v[152:155], v[24:27]
    ds_read_b128 v[160:163], v3 offset:832
    s_waitcnt lgkmcnt(5)
    v_mfma_f32_16x16x32_bf16 v[28:31], v[72:75], v[156:159], v[28:31]
    ds_read_b128 v[164:167], v3 offset:320
    v_mfma_f32_16x16x32_bf16 v[28:31], v[76:79], v[152:155], v[28:31]
    ds_read_b64 v[128:129], v2 offset:1344
    v_mfma_f32_16x16x32_bf16 v[32:35], v[76:79], v[156:159], v[32:35]
    ds_read_b64 v[130:131], v2 offset:1352
    s_waitcnt lgkmcnt(6)
    v_mfma_f32_16x16x32_bf16 v[32:35], v[104:107], v[152:155], v[32:35]
    ds_read_b64 v[132:133], v2 offset:1856
    v_mfma_f32_16x16x32_bf16 v[36:39], v[104:107], v[156:159], v[36:39]
    ds_read_b64 v[134:135], v2 offset:1864
    s_waitcnt lgkmcnt(6)
    v_mfma_f32_16x16x32_bf16 v[36:39], v[108:111], v[152:155], v[36:39]
    s_waitcnt lgkmcnt(5)
    v_mfma_f32_16x16x32_bf16 v[24:27], v[80:83], v[160:163], v[24:27]
    ds_read_b128 v[152:155], v3 offset:896
    s_waitcnt lgkmcnt(5)
    v_mfma_f32_16x16x32_bf16 v[28:31], v[80:83], v[164:167], v[28:31]
    ds_read_b128 v[156:159], v3 offset:384
    v_mfma_f32_16x16x32_bf16 v[28:31], v[84:87], v[160:163], v[28:31]
    ds_read_b64 v[104:105], v2 offset:1408
    v_mfma_f32_16x16x32_bf16 v[32:35], v[84:87], v[164:167], v[32:35]
    ds_read_b64 v[106:107], v2 offset:1416
    s_waitcnt lgkmcnt(6)
    v_mfma_f32_16x16x32_bf16 v[32:35], v[128:131], v[160:163], v[32:35]
    ds_read_b64 v[108:109], v2 offset:1920
    v_mfma_f32_16x16x32_bf16 v[36:39], v[128:131], v[164:167], v[36:39]
    ds_read_b64 v[110:111], v2 offset:1928
    s_waitcnt lgkmcnt(6)
    v_mfma_f32_16x16x32_bf16 v[36:39], v[132:135], v[160:163], v[36:39]
    s_waitcnt lgkmcnt(5)
    v_mfma_f32_16x16x32_bf16 v[24:27], v[88:91], v[152:155], v[24:27]
    ds_read_b128 v[160:163], v3 offset:960
    s_waitcnt lgkmcnt(5)
    v_mfma_f32_16x16x32_bf16 v[28:31], v[88:91], v[156:159], v[28:31]
    ds_read_b128 v[164:167], v3 offset:448
    v_mfma_f32_16x16x32_bf16 v[28:31], v[92:95], v[152:155], v[28:31]
    ds_read_b64 v[128:129], v2 offset:1472
    v_mfma_f32_16x16x32_bf16 v[32:35], v[92:95], v[156:159], v[32:35]
    ds_read_b64 v[130:131], v2 offset:1480
    s_waitcnt lgkmcnt(6)
    v_mfma_f32_16x16x32_bf16 v[32:35], v[104:107], v[152:155], v[32:35]
    ds_read_b64 v[132:133], v2 offset:1984
    v_mfma_f32_16x16x32_bf16 v[36:39], v[104:107], v[156:159], v[36:39]
    ds_read_b64 v[134:135], v2 offset:1992
    s_waitcnt lgkmcnt(6)
    v_mfma_f32_16x16x32_bf16 v[36:39], v[108:111], v[152:155], v[36:39]
    s_waitcnt lgkmcnt(5)
    v_mfma_f32_16x16x32_bf16 v[24:27], v[96:99], v[160:163], v[24:27]
    s_waitcnt lgkmcnt(4)
    v_mfma_f32_16x16x32_bf16 v[28:31], v[96:99], v[164:167], v[28:31]
    v_mfma_f32_16x16x32_bf16 v[28:31], v[100:103], v[160:163], v[28:31]
    v_mfma_f32_16x16x32_bf16 v[32:35], v[100:103], v[164:167], v[32:35]
    s_waitcnt lgkmcnt(2)
    v_mfma_f32_16x16x32_bf16 v[32:35], v[128:131], v[160:163], v[32:35]
    v_mfma_f32_16x16x32_bf16 v[36:39], v[128:131], v[164:167], v[36:39]
    s_waitcnt lgkmcnt(0)
    v_mfma_f32_16x16x32_bf16 v[36:39], v[132:135], v[160:163], v[36:39]
    s_nop 7
    s_nop 1
    v_cvt_pk_bf16_f32 v24, v24, v25
    v_cvt_pk_bf16_f32 v25, v26, v27
    ds_write_b64 v5, v[24:25] offset:8320
    v_cvt_pk_bf16_f32 v28, v28, v29
    v_cvt_pk_bf16_f32 v29, v30, v31
    ds_write_b64 v5, v[28:29] offset:8832
    s_waitcnt lgkmcnt(0)
    s_barrier
    ds_read_b128 v[152:155], v3 offset:2560
    ds_read_b128 v[156:159], v3 offset:2048
    s_waitcnt lgkmcnt(1)
    v_mfma_f32_16x16x32_bf16 v[32:35], v[40:43], v[152:155], v[32:35]
    ds_read_b128 v[160:163], v3 offset:2624
    s_waitcnt lgkmcnt(1)
    v_mfma_f32_16x16x32_bf16 v[36:39], v[40:43], v[156:159], v[36:39]
    ds_read_b128 v[164:167], v3 offset:2112
    v_mfma_f32_16x16x32_bf16 v[36:39], v[44:47], v[152:155], v[36:39]
    s_waitcnt lgkmcnt(1)
    v_mfma_f32_16x16x32_bf16 v[32:35], v[48:51], v[160:163], v[32:35]
    ds_read_b128 v[152:155], v3 offset:2688
    s_waitcnt lgkmcnt(1)
    v_mfma_f32_16x16x32_bf16 v[36:39], v[48:51], v[164:167], v[36:39]
    ds_read_b128 v[156:159], v3 offset:2176
    v_mfma_f32_16x16x32_bf16 v[36:39], v[52:55], v[160:163], v[36:39]
    s_waitcnt lgkmcnt(1)
    v_mfma_f32_16x16x32_bf16 v[32:35], v[56:59], v[152:155], v[32:35]
    ds_read_b128 v[160:163], v3 offset:2752
    s_waitcnt lgkmcnt(1)
    v_mfma_f32_16x16x32_bf16 v[36:39], v[56:59], v[156:159], v[36:39]
    ds_read_b128 v[164:167], v3 offset:2240
    v_mfma_f32_16x16x32_bf16 v[36:39], v[60:63], v[152:155], v[36:39]
    s_waitcnt lgkmcnt(1)
    v_mfma_f32_16x16x32_bf16 v[32:35], v[64:67], v[160:163], v[32:35]
    ds_read_b128 v[152:155], v3 offset:2816
    s_waitcnt lgkmcnt(1)
    v_mfma_f32_16x16x32_bf16 v[36:39], v[64:67], v[164:167], v[36:39]
    ds_read_b128 v[156:159], v3 offset:2304
    v_mfma_f32_16x16x32_bf16 v[36:39], v[68:71], v[160:163], v[36:39]
    s_waitcnt lgkmcnt(1)
    v_mfma_f32_16x16x32_bf16 v[32:35], v[72:75], v[152:155], v[32:35]
    ds_read_b128 v[160:163], v3 offset:2880
    s_waitcnt lgkmcnt(1)
    v_mfma_f32_16x16x32_bf16 v[36:39], v[72:75], v[156:159], v[36:39]
    ds_read_b128 v[164:167], v3 offset:2368
    v_mfma_f32_16x16x32_bf16 v[36:39], v[76:79], v[152:155], v[36:39]
    s_waitcnt lgkmcnt(1)
    v_mfma_f32_16x16x32_bf16 v[32:35], v[80:83], v[160:163], v[32:35]
    ds_read_b128 v[152:155], v3 offset:2944
    s_waitcnt lgkmcnt(1)
    v_mfma_f32_16x16x32_bf16 v[36:39], v[80:83], v[164:167], v[36:39]
    ds_read_b128 v[156:159], v3 offset:2432
    v_mfma_f32_16x16x32_bf16 v[36:39], v[84:87], v[160:163], v[36:39]
    s_waitcnt lgkmcnt(1)
    v_mfma_f32_16x16x32_bf16 v[32:35], v[88:91], v[152:155], v[32:35]
    ds_read_b128 v[160:163], v3 offset:3008
    s_waitcnt lgkmcnt(1)
    v_mfma_f32_16x16x32_bf16 v[36:39], v[88:91], v[156:159], v[36:39]
    ds_read_b128 v[164:167], v3 offset:2496
    v_mfma_f32_16x16x32_bf16 v[36:39], v[92:95], v[152:155], v[36:39]
    s_waitcnt lgkmcnt(1)
    v_mfma_f32_16x16x32_bf16 v[32:35], v[96:99], v[160:163], v[32:35]
    s_waitcnt lgkmcnt(0)
    v_mfma_f32_16x16x32_bf16 v[36:39], v[96:99], v[164:167], v[36:39]
    v_mfma_f32_16x16x32_bf16 v[36:39], v[100:103], v[160:163], v[36:39]
    s_nop 7
    s_nop 1
    v_cvt_pk_bf16_f32 v32, v32, v33
    v_cvt_pk_bf16_f32 v33, v34, v35
    ds_write_b64 v5, v[32:33] offset:12480
    v_cvt_pk_bf16_f32 v36, v36, v37
    v_cvt_pk_bf16_f32 v37, v38, v39
    ds_write_b64 v5, v[36:37] offset:12992
    s_waitcnt lgkmcnt(0)
    s_barrier
    s_endpgm
L_servA:
    v_subrev_u32 v0, 512, v0
    s_waitcnt lgkmcnt(0)
    s_mov_b32 s44, s6
    s_and_b32 s45, s7, 0xffff
    s_mov_b32 s46, 0x280000
    s_mov_b32 s47, 0x00020000
    v_and_b32 v32, 15, v0
    v_bfe_u32 v33, v0, 4, 1
    v_lshrrev_b32 v34, 6, v0
    v_lshl_add_u32 v32, v34, 4, v32
    v_lshl_add_u32 v32, v33, 9, v32
    s_lshl_b32 s99, s42, 6
    v_add_u32 v32, s99, v32
    v_mul_u32_u24 v32, 1280, v32
    s_lshl_b32 s100, s41, 7
    buffer_load_dword v33, v32, s[44:47], s100 offen
    s_mov_b32 s48, s8
    s_and_b32 s49, s9, 0xffff
    s_mov_b32 s50, 0x280000
    s_mov_b32 s51, 0x00020000
    s_mov_b32 s52, s4
    s_and_b32 s53, s5, 0xffff
    s_mov_b32 s54, 0x280000
    s_mov_b32 s55, 0x00020000
    s_mov_b32 s60, s34
    s_and_b32 s61, s35, 0xffff
    s_mov_b32 s62, 0x500000
    s_mov_b32 s63, 0x00020000
    s_lshl_b32 s99, s43, 3
    s_add_u32 s100, s10, s99
    s_addc_u32 s101, s11, 0
    s_load_dwordx16 s[20:35], s[100:101], 0
    s_lshl_b32 s99, s43, 1
    s_add_u32 s100, s14, s99
    s_addc_u32 s101, s15, 0
    s_load_dwordx4 s[92:95], s[100:101], 0
    s_lshl_b32 s99, s43, 1
    v_mul_u32_u24 v34, 2560, v0
    v_add_u32 v8, s99, v34
    s_add_u32 s99, s99, 0
    v_lshl_add_u32 v9, v34, 1, s99
    v_lshlrev_b32 v34, 2, v0
    v_sub_u32 v10, 136188, v34
    v_add_u32 v12, 3136, v34
    v_add_u32 v13, 70720, v34
    v_and_b32 v34, 28, v34
    v_add_u32 v34, 138720, v34
    v_add_u32 v11, 3072, v10
    v_cmp_gt_u32 vcc, 128, v0
    s_waitcnt lgkmcnt(0)
    s_lshl_b32 s4, s92, 16
    s_and_b32 s5, s92, 0xffff0000
    s_lshl_b32 s6, s93, 16
    s_and_b32 s7, s93, 0xffff0000
    s_lshl_b32 s8, s94, 16
    s_and_b32 s9, s94, 0xffff0000
    s_lshl_b32 s10, s95, 16
    s_and_b32 s11, s95, 0xffff0000
    v_cndmask_b32 v11, v11, v34, vcc
    s_lshl_b32 s64, s20, 16
    s_and_b32 s65, s20, 0xffff0000
    s_lshl_b32 s66, s21, 16
    s_and_b32 s67, s21, 0xffff0000
    s_lshl_b32 s68, s22, 16
    s_and_b32 s69, s22, 0xffff0000
    s_lshl_b32 s70, s23, 16
    s_and_b32 s71, s23, 0xffff0000
    s_lshl_b32 s72, s24, 16
    s_and_b32 s73, s24, 0xffff0000
    s_lshl_b32 s74, s25, 16
    s_and_b32 s75, s25, 0xffff0000
    s_lshl_b32 s76, s26, 16
    s_and_b32 s77, s26, 0xffff0000
    s_lshl_b32 s78, s27, 16
    s_and_b32 s79, s27, 0xffff0000
    s_lshl_b32 s80, s28, 16
    s_and_b32 s81, s28, 0xffff0000
    s_lshl_b32 s82, s29, 16
    s_and_b32 s83, s29, 0xffff0000
    s_lshl_b32 s84, s30, 16
    s_and_b32 s85, s30, 0xffff0000
    s_lshl_b32 s86, s31, 16
    s_and_b32 s87, s31, 0xffff0000
    s_lshl_b32 s88, s32, 16
    s_and_b32 s89, s32, 0xffff0000
    s_lshl_b32 s90, s33, 16
    s_and_b32 s91, s33, 0xffff0000
    s_lshl_b32 s92, s34, 16
    s_and_b32 s93, s34, 0xffff0000
    s_lshl_b32 s94, s35, 16
    s_and_b32 s95, s35, 0xffff0000
    s_mov_b32 s23, 655360
    s_mov_b32 s32, 1310720
    s_mov_b32 s24, 1310720
    s_mov_b32 s33, 2621440
    s_mov_b32 s25, 1966080
    s_mov_b32 s34, 3932160
    s_setprio 3
    s_waitcnt vmcnt(0)
    v_add_u32 v14, -3840, v8
    s_mov_b64 exec, 1
    buffer_load_dwordx4 v[64:67], v14, s[44:47], 0 offen offset:0
    buffer_load_dwordx4 v[68:71], v14, s[44:47], 0 offen offset:1280
    buffer_load_dwordx4 v[72:75], v14, s[44:47], 0 offen offset:2560
    s_mov_b64 exec, -1
    buffer_load_dwordx4 v[76:79], v8, s[44:47], 0 offen offset:0
    buffer_load_dwordx4 v[80:83], v8, s[44:47], 0 offen offset:1280
    buffer_load_dwordx4 v[84:87], v8, s[48:51], 0 offen offset:0
    buffer_load_dwordx4 v[88:91], v8, s[48:51], 0 offen offset:1280
    s_waitcnt vmcnt(0)
    v_mov_b32_dpp v72, v80 wave_shr:1 row_mask:0xf bank_mask:0xf
    v_mov_b32_dpp v73, v81 wave_shr:1 row_mask:0xf bank_mask:0xf
    v_mov_b32_dpp v74, v82 wave_shr:1 row_mask:0xf bank_mask:0xf
    v_mov_b32_dpp v75, v83 wave_shr:1 row_mask:0xf bank_mask:0xf
    v_mov_b32_dpp v68, v76 wave_shr:1 row_mask:0xf bank_mask:0xf
    v_mov_b32_dpp v69, v77 wave_shr:1 row_mask:0xf bank_mask:0xf
    v_mov_b32_dpp v70, v78 wave_shr:1 row_mask:0xf bank_mask:0xf
    v_mov_b32_dpp v71, v79 wave_shr:1 row_mask:0xf bank_mask:0xf
    v_mov_b32_dpp v64, v72 wave_shr:1 row_mask:0xf bank_mask:0xf
    v_mov_b32_dpp v65, v73 wave_shr:1 row_mask:0xf bank_mask:0xf
    v_mov_b32_dpp v66, v74 wave_shr:1 row_mask:0xf bank_mask:0xf
    v_mov_b32_dpp v67, v75 wave_shr:1 row_mask:0xf bank_mask:0xf
    v_lshlrev_b32 v120, 16, v64
    v_and_b32 v121, 0xffff0000, v64
    v_lshlrev_b32 v122, 16, v65
    v_and_b32 v123, 0xffff0000, v65
    v_lshlrev_b32 v124, 16, v66
    v_and_b32 v125, 0xffff0000, v66
    v_lshlrev_b32 v126, 16, v67
    v_and_b32 v127, 0xffff0000, v67
    v_mul_f32 v128, s67, v120
    v_mul_f32 v129, s71, v121
    v_mul_f32 v130, s75, v122
    v_mul_f32 v131, s79, v123
    v_mul_f32 v132, s83, v124
    v_mul_f32 v133, s87, v125
    v_mul_f32 v134, s91, v126
    v_mul_f32 v135, s95, v127
    v_lshlrev_b32 v120, 16, v68
    v_and_b32 v121, 0xffff0000, v68
    v_lshlrev_b32 v122, 16, v69
    v_and_b32 v123, 0xffff0000, v69
    v_lshlrev_b32 v124, 16, v70
    v_and_b32 v125, 0xffff0000, v70
    v_lshlrev_b32 v126, 16, v71
    v_and_b32 v127, 0xffff0000, v71
    v_fmac_f32 v128, s66, v120
    v_fmac_f32 v129, s70, v121
    v_fmac_f32 v130, s74, v122
    v_fmac_f32 v131, s78, v123
    v_fmac_f32 v132, s82, v124
    v_fmac_f32 v133, s86, v125
    v_fmac_f32 v134, s90, v126
    v_fmac_f32 v135, s94, v127
    v_mul_f32 v136, s67, v120
    v_mul_f32 v137, s71, v121
    v_mul_f32 v138, s75, v122
    v_mul_f32 v139, s79, v123
    v_mul_f32 v140, s83, v124
    v_mul_f32 v141, s87, v125
    v_mul_f32 v142, s91, v126
    v_mul_f32 v143, s95, v127
    v_lshlrev_b32 v120, 16, v72
    v_and_b32 v121, 0xffff0000, v72
    v_lshlrev_b32 v122, 16, v73
    v_and_b32 v123, 0xffff0000, v73
    v_lshlrev_b32 v124, 16, v74
    v_and_b32 v125, 0xffff0000, v74
    v_lshlrev_b32 v126, 16, v75
    v_and_b32 v127, 0xffff0000, v75
    v_fmac_f32 v128, s65, v120
    v_fmac_f32 v129, s69, v121
    v_fmac_f32 v130, s73, v122
    v_fmac_f32 v131, s77, v123
    v_fmac_f32 v132, s81, v124
    v_fmac_f32 v133, s85, v125
    v_fmac_f32 v134, s89, v126
    v_fmac_f32 v135, s93, v127
    v_fmac_f32 v136, s66, v120
    v_fmac_f32 v137, s70, v121
    v_fmac_f32 v138, s74, v122
    v_fmac_f32 v139, s78, v123
    v_fmac_f32 v140, s82, v124
    v_fmac_f32 v141, s86, v125
    v_fmac_f32 v142, s90, v126
    v_fmac_f32 v143, s94, v127
    v_lshlrev_b32 v120, 16, v76
    v_and_b32 v121, 0xffff0000, v76
    v_lshlrev_b32 v122, 16, v77
    v_and_b32 v123, 0xffff0000, v77
    v_lshlrev_b32 v124, 16, v78
    v_and_b32 v125, 0xffff0000, v78
    v_lshlrev_b32 v126, 16, v79
    v_and_b32 v127, 0xffff0000, v79
    v_fmac_f32 v128, s64, v120
    v_fmac_f32 v129, s68, v121
    v_fmac_f32 v130, s72, v122
    v_fmac_f32 v131, s76, v123
    v_fmac_f32 v132, s80, v124
    v_fmac_f32 v133, s84, v125
    v_fmac_f32 v134, s88, v126
    v_fmac_f32 v135, s92, v127
    v_fmac_f32 v136, s65, v120
    v_fmac_f32 v137, s69, v121
    v_fmac_f32 v138, s73, v122
    v_fmac_f32 v139, s77, v123
    v_fmac_f32 v140, s81, v124
    v_fmac_f32 v141, s85, v125
    v_fmac_f32 v142, s89, v126
    v_fmac_f32 v143, s93, v127
    v_lshlrev_b32 v120, 16, v80
    v_and_b32 v121, 0xffff0000, v80
    v_lshlrev_b32 v122, 16, v81
    v_and_b32 v123, 0xffff0000, v81
    v_lshlrev_b32 v124, 16, v82
    v_and_b32 v125, 0xffff0000, v82
    v_lshlrev_b32 v126, 16, v83
    v_and_b32 v127, 0xffff0000, v83
    v_fmac_f32 v136, s64, v120
    v_fmac_f32 v137, s68, v121
    v_fmac_f32 v138, s72, v122
    v_fmac_f32 v139, s76, v123
    v_fmac_f32 v140, s80, v124
    v_fmac_f32 v141, s84, v125
    v_fmac_f32 v142, s88, v126
    v_fmac_f32 v143, s92, v127
    v_lshlrev_b32 v120, 16, v84
    v_and_b32 v121, 0xffff0000, v84
    v_lshlrev_b32 v122, 16, v85
    v_and_b32 v123, 0xffff0000, v85
    v_lshlrev_b32 v124, 16, v86
    v_and_b32 v125, 0xffff0000, v86
    v_lshlrev_b32 v126, 16, v87
    v_and_b32 v127, 0xffff0000, v87
    v_mul_f32 v128, v128, v120
    v_mul_f32 v129, v129, v121
    v_mul_f32 v130, v130, v122
    v_mul_f32 v131, v131, v123
    v_mul_f32 v132, v132, v124
    v_mul_f32 v133, v133, v125
    v_mul_f32 v134, v134, v126
    v_mul_f32 v135, v135, v127
    v_lshlrev_b32 v120, 16, v88
    v_and_b32 v121, 0xffff0000, v88
    v_lshlrev_b32 v122, 16, v89
    v_and_b32 v123, 0xffff0000, v89
    v_lshlrev_b32 v124, 16, v90
    v_and_b32 v125, 0xffff0000, v90
    v_lshlrev_b32 v126, 16, v91
    v_and_b32 v127, 0xffff0000, v91
    v_mul_f32 v136, v136, v120
    v_mul_f32 v137, v137, v121
    v_mul_f32 v138, v138, v122
    v_mul_f32 v139, v139, v123
    v_mul_f32 v140, v140, v124
    v_mul_f32 v141, v141, v125
    v_mul_f32 v142, v142, v126
    v_mul_f32 v143, v143, v127
    v_cvt_pk_bf16_f32 v16, v136, v128
    v_cvt_pk_bf16_f32 v17, v137, v129
    v_cvt_pk_bf16_f32 v18, v138, v130
    v_cvt_pk_bf16_f32 v19, v139, v131
    v_cvt_pk_bf16_f32 v20, v140, v132
    v_cvt_pk_bf16_f32 v21, v141, v133
    v_cvt_pk_bf16_f32 v22, v142, v134
    v_cvt_pk_bf16_f32 v23, v143, v135
    ds_write_b32 v10, v16 offset:2048
    ds_write_b32 v10, v17 offset:5632
    ds_write_b32 v10, v18 offset:9216
    ds_write_b32 v10, v19 offset:12800
    ds_write_b32 v10, v20 offset:16384
    ds_write_b32 v10, v21 offset:19968
    ds_write_b32 v10, v22 offset:23552
    ds_write_b32 v10, v23 offset:27136
    s_waitcnt lgkmcnt(0)
    s_barrier
    v_add_u32 v14, 651520, v8
    s_mov_b64 exec, 1
    buffer_load_dwordx4 v[92:95], v14, s[44:47], 0 offen offset:0
    buffer_load_dwordx4 v[96:99], v14, s[44:47], 0 offen offset:1280
    buffer_load_dwordx4 v[100:103], v14, s[44:47], 0 offen offset:2560
    s_mov_b64 exec, -1
    buffer_load_dwordx4 v[104:107], v8, s[44:47], s23 offen offset:0
    buffer_load_dwordx4 v[108:111], v8, s[44:47], s23 offen offset:1280
    buffer_load_dwordx4 v[112:115], v8, s[48:51], s23 offen offset:0
    buffer_load_dwordx4 v[116:119], v8, s[48:51], s23 offen offset:1280
    v_add_u32 v14, 1306880, v8
    s_mov_b64 exec, 1
    buffer_load_dwordx4 v[64:67], v14, s[44:47], 0 offen offset:0
    buffer_load_dwordx4 v[68:71], v14, s[44:47], 0 offen offset:1280
    buffer_load_dwordx4 v[72:75], v14, s[44:47], 0 offen offset:2560
    s_mov_b64 exec, -1
    s_waitcnt vmcnt(3)
    v_mov_b32_dpp v100, v108 wave_shr:1 row_mask:0xf bank_mask:0xf
    v_mov_b32_dpp v101, v109 wave_shr:1 row_mask:0xf bank_mask:0xf
    v_mov_b32_dpp v102, v110 wave_shr:1 row_mask:0xf bank_mask:0xf
    v_mov_b32_dpp v103, v111 wave_shr:1 row_mask:0xf bank_mask:0xf
    v_mov_b32_dpp v96, v104 wave_shr:1 row_mask:0xf bank_mask:0xf
    v_mov_b32_dpp v97, v105 wave_shr:1 row_mask:0xf bank_mask:0xf
    v_mov_b32_dpp v98, v106 wave_shr:1 row_mask:0xf bank_mask:0xf
    v_mov_b32_dpp v99, v107 wave_shr:1 row_mask:0xf bank_mask:0xf
    v_mov_b32_dpp v92, v100 wave_shr:1 row_mask:0xf bank_mask:0xf
    v_mov_b32_dpp v93, v101 wave_shr:1 row_mask:0xf bank_mask:0xf
    v_mov_b32_dpp v94, v102 wave_shr:1 row_mask:0xf bank_mask:0xf
    v_mov_b32_dpp v95, v103 wave_shr:1 row_mask:0xf bank_mask:0xf
    v_lshlrev_b32 v120, 16, v92
    v_and_b32 v121, 0xffff0000, v92
    v_lshlrev_b32 v122, 16, v93
    v_and_b32 v123, 0xffff0000, v93
    v_lshlrev_b32 v124, 16, v94
    v_and_b32 v125, 0xffff0000, v94
    v_lshlrev_b32 v126, 16, v95
    buffer_load_dwordx4 v[76:79], v8, s[44:47], s24 offen offset:0
    v_and_b32 v127, 0xffff0000, v95
    v_mul_f32 v128, s67, v120
    v_mul_f32 v129, s71, v121
    v_mul_f32 v130, s75, v122
    v_mul_f32 v131, s79, v123
    v_mul_f32 v132, s83, v124
    v_mul_f32 v133, s87, v125
    v_mul_f32 v134, s91, v126
    v_mul_f32 v135, s95, v127
    v_lshlrev_b32 v120, 16, v96
    v_and_b32 v121, 0xffff0000, v96
    v_lshlrev_b32 v122, 16, v97
    v_and_b32 v123, 0xffff0000, v97
    v_lshlrev_b32 v124, 16, v98
    v_and_b32 v125, 0xffff0000, v98
    v_lshlrev_b32 v126, 16, v99
    v_and_b32 v127, 0xffff0000, v99
    v_fmac_f32 v128, s66, v120
    v_fmac_f32 v129, s70, v121
    v_fmac_f32 v130, s74, v122
    buffer_load_dwordx4 v[80:83], v8, s[44:47], s24 offen offset:1280
    v_fmac_f32 v131, s78, v123
    v_fmac_f32 v132, s82, v124
    v_fmac_f32 v133, s86, v125
    v_fmac_f32 v134, s90, v126
    v_fmac_f32 v135, s94, v127
    v_mul_f32 v136, s67, v120
    v_mul_f32 v137, s71, v121
    v_mul_f32 v138, s75, v122
    v_mul_f32 v139, s79, v123
    v_mul_f32 v140, s83, v124
    v_mul_f32 v141, s87, v125
    v_mul_f32 v142, s91, v126
    v_mul_f32 v143, s95, v127
    v_lshlrev_b32 v120, 16, v100
    v_and_b32 v121, 0xffff0000, v100
    v_lshlrev_b32 v122, 16, v101
    v_and_b32 v123, 0xffff0000, v101
    v_lshlrev_b32 v124, 16, v102
    v_and_b32 v125, 0xffff0000, v102
    v_lshlrev_b32 v126, 16, v103
    buffer_load_dwordx4 v[84:87], v8, s[48:51], s24 offen offset:0
    v_and_b32 v127, 0xffff0000, v103
    v_fmac_f32 v128, s65, v120
    v_fmac_f32 v129, s69, v121
    v_fmac_f32 v130, s73, v122
    v_fmac_f32 v131, s77, v123
    v_fmac_f32 v132, s81, v124
    v_fmac_f32 v133, s85, v125
    v_fmac_f32 v134, s89, v126
    v_fmac_f32 v135, s93, v127
    v_fmac_f32 v136, s66, v120
    v_fmac_f32 v137, s70, v121
    v_fmac_f32 v138, s74, v122
    v_fmac_f32 v139, s78, v123
    v_fmac_f32 v140, s82, v124
    v_fmac_f32 v141, s86, v125
    v_fmac_f32 v142, s90, v126
    v_fmac_f32 v143, s94, v127
    v_lshlrev_b32 v120, 16, v104
    v_and_b32 v121, 0xffff0000, v104
    v_lshlrev_b32 v122, 16, v105
    buffer_load_dwordx4 v[88:91], v8, s[48:51], s24 offen offset:1280
    v_and_b32 v123, 0xffff0000, v105
    v_lshlrev_b32 v124, 16, v106
    v_and_b32 v125, 0xffff0000, v106
    v_lshlrev_b32 v126, 16, v107
    v_and_b32 v127, 0xffff0000, v107
    v_fmac_f32 v128, s64, v120
    v_fmac_f32 v129, s68, v121
    v_fmac_f32 v130, s72, v122
    v_fmac_f32 v131, s76, v123
    v_fmac_f32 v132, s80, v124
    v_fmac_f32 v133, s84, v125
    v_fmac_f32 v134, s88, v126
    v_fmac_f32 v135, s92, v127
    v_fmac_f32 v136, s65, v120
    v_fmac_f32 v137, s69, v121
    v_fmac_f32 v138, s73, v122
    v_fmac_f32 v139, s77, v123
    v_fmac_f32 v140, s81, v124
    v_fmac_f32 v141, s85, v125
    v_fmac_f32 v142, s89, v126
    buffer_load_dwordx4 v[48:51], v8, s[52:55], 0 offen offset:0
    v_fmac_f32 v143, s93, v127
    v_lshlrev_b32 v120, 16, v108
    v_and_b32 v121, 0xffff0000, v108
    v_lshlrev_b32 v122, 16, v109
    v_and_b32 v123, 0xffff0000, v109
    v_lshlrev_b32 v124, 16, v110
    v_and_b32 v125, 0xffff0000, v110
    v_lshlrev_b32 v126, 16, v111
    v_and_b32 v127, 0xffff0000, v111
    v_fmac_f32 v136, s64, v120
    v_fmac_f32 v137, s68, v121
    v_fmac_f32 v138, s72, v122
    v_fmac_f32 v139, s76, v123
    v_fmac_f32 v140, s80, v124
    v_fmac_f32 v141, s84, v125
    v_fmac_f32 v142, s88, v126
    v_fmac_f32 v143, s92, v127
    v_lshlrev_b32 v120, 16, v112
    v_and_b32 v121, 0xffff0000, v112
    v_lshlrev_b32 v122, 16, v113
    buffer_load_dwordx4 v[52:55], v8, s[52:55], 0 offen offset:1280
    v_and_b32 v123, 0xffff0000, v113
    v_lshlrev_b32 v124, 16, v114
    v_and_b32 v125, 0xffff0000, v114
    v_lshlrev_b32 v126, 16, v115
    v_and_b32 v127, 0xffff0000, v115
    v_mul_f32 v128, v128, v120
    v_mul_f32 v129, v129, v121
    v_mul_f32 v130, v130, v122
    v_mul_f32 v131, v131, v123
    v_mul_f32 v132, v132, v124
    v_mul_f32 v133, v133, v125
    v_mul_f32 v134, v134, v126
    v_mul_f32 v135, v135, v127
    v_lshlrev_b32 v120, 16, v116
    v_and_b32 v121, 0xffff0000, v116
    v_lshlrev_b32 v122, 16, v117
    v_and_b32 v123, 0xffff0000, v117
    v_lshlrev_b32 v124, 16, v118
    v_and_b32 v125, 0xffff0000, v118
    v_lshlrev_b32 v126, 16, v119
    v_and_b32 v127, 0xffff0000, v119
    v_mul_f32 v136, v136, v120
    v_mul_f32 v137, v137, v121
    v_mul_f32 v138, v138, v122
    v_mul_f32 v139, v139, v123
    v_mul_f32 v140, v140, v124
    v_mul_f32 v141, v141, v125
    v_mul_f32 v142, v142, v126
    v_mul_f32 v143, v143, v127
    v_cvt_pk_bf16_f32 v24, v136, v128
    v_cvt_pk_bf16_f32 v25, v137, v129
    v_cvt_pk_bf16_f32 v26, v138, v130
    v_cvt_pk_bf16_f32 v27, v139, v131
    v_cvt_pk_bf16_f32 v28, v140, v132
    v_cvt_pk_bf16_f32 v29, v141, v133
    v_cvt_pk_bf16_f32 v30, v142, v134
    v_cvt_pk_bf16_f32 v31, v143, v135
    ds_write_b32 v10, v24 offset:1024
    ds_write_b32 v10, v25 offset:4608
    ds_write_b32 v10, v26 offset:8192
    ds_write_b32 v10, v27 offset:11776
    ds_write_b32 v10, v28 offset:15360
    ds_write_b32 v10, v29 offset:18944
    ds_write_b32 v10, v30 offset:22528
    ds_write_b32 v10, v31 offset:26112
    s_waitcnt lgkmcnt(0)
    s_barrier
    v_add_u32 v14, 1962240, v8
    s_mov_b64 exec, 1
    buffer_load_dwordx4 v[92:95], v14, s[44:47], 0 offen offset:0
    buffer_load_dwordx4 v[96:99], v14, s[44:47], 0 offen offset:1280
    buffer_load_dwordx4 v[100:103], v14, s[44:47], 0 offen offset:2560
    s_mov_b64 exec, -1
    ds_read_b32 v144, v12 offset:0
    ds_read_b32 v145, v12 offset:16896
    ds_read_b32 v146, v12 offset:33792
    ds_read_b32 v147, v12 offset:50688
    ds_read_b32 v148, v13 offset:0
    ds_read_b32 v149, v13 offset:16896
    ds_read_b32 v150, v13 offset:33792
    ds_read_b32 v151, v13 offset:50688
    v_and_b32 v120, 0xffff0000, v16
    v_and_b32 v121, 0xffff0000, v17
    v_and_b32 v122, 0xffff0000, v18
    v_and_b32 v123, 0xffff0000, v19
    v_and_b32 v124, 0xffff0000, v20
    v_and_b32 v125, 0xffff0000, v21
    v_and_b32 v126, 0xffff0000, v22
    v_and_b32 v127, 0xffff0000, v23
    s_waitcnt lgkmcnt(0)
    v_lshlrev_b32 v128, 16, v144
    v_lshlrev_b32 v129, 16, v145
    v_lshlrev_b32 v130, 16, v146
    v_lshlrev_b32 v131, 16, v147
    v_lshlrev_b32 v132, 16, v148
    v_lshlrev_b32 v133, 16, v149
    v_lshlrev_b32 v134, 16, v150
    v_lshlrev_b32 v135, 16, v151
    v_fmac_f32 v128, s4, v120
    v_fmac_f32 v129, s5, v121
    v_fmac_f32 v130, s6, v122
    v_fmac_f32 v131, s7, v123
    v_fmac_f32 v132, s8, v124
    v_fmac_f32 v133, s9, v125
    v_fmac_f32 v134, s10, v126
    v_fmac_f32 v135, s11, v127
    buffer_load_dwordx4 v[104:107], v8, s[44:47], s25 offen offset:0
    s_waitcnt vmcnt(4)
    v_lshlrev_b32 v120, 16, v48
    v_and_b32 v121, 0xffff0000, v48
    v_lshlrev_b32 v122, 16, v49
    v_and_b32 v123, 0xffff0000, v49
    v_lshlrev_b32 v124, 16, v50
    v_and_b32 v125, 0xffff0000, v50
    v_lshlrev_b32 v126, 16, v51
    v_and_b32 v127, 0xffff0000, v51
    v_mul_f32 v128, v128, v120
    v_mul_f32 v129, v129, v121
    v_mul_f32 v130, v130, v122
    v_mul_f32 v131, v131, v123
    v_mul_f32 v132, v132, v124
    v_mul_f32 v133, v133, v125
    v_mul_f32 v134, v134, v126
    v_mul_f32 v135, v135, v127
    v_cvt_pk_bf16_f32 v152, v128, v129
    v_cvt_pk_bf16_f32 v153, v130, v131
    v_cvt_pk_bf16_f32 v154, v132, v133
    v_cvt_pk_bf16_f32 v155, v134, v135
    buffer_store_dwordx4 v[152:155], v9, s[60:63], 0 offen offset:0
    v_lshlrev_b32 v120, 16, v16
    v_lshlrev_b32 v121, 16, v17
    v_lshlrev_b32 v122, 16, v18
    v_lshlrev_b32 v123, 16, v19
    v_lshlrev_b32 v124, 16, v20
    v_lshlrev_b32 v125, 16, v21
    v_lshlrev_b32 v126, 16, v22
    v_lshlrev_b32 v127, 16, v23
    v_and_b32 v128, 0xffff0000, v144
    v_and_b32 v129, 0xffff0000, v145
    v_and_b32 v130, 0xffff0000, v146
    buffer_load_dwordx4 v[108:111], v8, s[44:47], s25 offen offset:1280
    v_and_b32 v131, 0xffff0000, v147
    v_and_b32 v132, 0xffff0000, v148
    v_and_b32 v133, 0xffff0000, v149
    v_and_b32 v134, 0xffff0000, v150
    v_and_b32 v135, 0xffff0000, v151
    v_fmac_f32 v128, s4, v120
    v_fmac_f32 v129, s5, v121
    v_fmac_f32 v130, s6, v122
    v_fmac_f32 v131, s7, v123
    v_fmac_f32 v132, s8, v124
    v_fmac_f32 v133, s9, v125
    v_fmac_f32 v134, s10, v126
    v_fmac_f32 v135, s11, v127
    v_lshlrev_b32 v120, 16, v52
    v_and_b32 v121, 0xffff0000, v52
    v_lshlrev_b32 v122, 16, v53
    v_and_b32 v123, 0xffff0000, v53
    v_lshlrev_b32 v124, 16, v54
    v_and_b32 v125, 0xffff0000, v54
    v_lshlrev_b32 v126, 16, v55
    v_and_b32 v127, 0xffff0000, v55
    v_mul_f32 v128, v128, v120
    v_mul_f32 v129, v129, v121
    v_mul_f32 v130, v130, v122
    v_mul_f32 v131, v131, v123
    v_mul_f32 v132, v132, v124
    v_mul_f32 v133, v133, v125
    v_mul_f32 v134, v134, v126
    v_mul_f32 v135, v135, v127
    v_cvt_pk_bf16_f32 v156, v128, v129
    v_cvt_pk_bf16_f32 v157, v130, v131
    v_cvt_pk_bf16_f32 v158, v132, v133
    v_cvt_pk_bf16_f32 v159, v134, v135
    buffer_load_dwordx4 v[112:115], v8, s[48:51], s25 offen offset:0
    buffer_store_dwordx4 v[156:159], v9, s[60:63], 0 offen offset:2560
    s_waitcnt vmcnt(10)
    v_mov_b32_dpp v72, v80 wave_shr:1 row_mask:0xf bank_mask:0xf
    v_mov_b32_dpp v73, v81 wave_shr:1 row_mask:0xf bank_mask:0xf
    v_mov_b32_dpp v74, v82 wave_shr:1 row_mask:0xf bank_mask:0xf
    v_mov_b32_dpp v75, v83 wave_shr:1 row_mask:0xf bank_mask:0xf
    v_mov_b32_dpp v68, v76 wave_shr:1 row_mask:0xf bank_mask:0xf
    v_mov_b32_dpp v69, v77 wave_shr:1 row_mask:0xf bank_mask:0xf
    v_mov_b32_dpp v70, v78 wave_shr:1 row_mask:0xf bank_mask:0xf
    v_mov_b32_dpp v71, v79 wave_shr:1 row_mask:0xf bank_mask:0xf
    v_mov_b32_dpp v64, v72 wave_shr:1 row_mask:0xf bank_mask:0xf
    v_mov_b32_dpp v65, v73 wave_shr:1 row_mask:0xf bank_mask:0xf
    v_mov_b32_dpp v66, v74 wave_shr:1 row_mask:0xf bank_mask:0xf
    v_mov_b32_dpp v67, v75 wave_shr:1 row_mask:0xf bank_mask:0xf
    v_lshlrev_b32 v120, 16, v64
    v_and_b32 v121, 0xffff0000, v64
    v_lshlrev_b32 v122, 16, v65
    v_and_b32 v123, 0xffff0000, v65
    v_lshlrev_b32 v124, 16, v66
    v_and_b32 v125, 0xffff0000, v66
    v_lshlrev_b32 v126, 16, v67
    v_and_b32 v127, 0xffff0000, v67
    v_mul_f32 v128, s67, v120
    v_mul_f32 v129, s71, v121
    v_mul_f32 v130, s75, v122
    v_mul_f32 v131, s79, v123
    v_mul_f32 v132, s83, v124
    v_mul_f32 v133, s87, v125
    v_mul_f32 v134, s91, v126
    v_mul_f32 v135, s95, v127
    v_lshlrev_b32 v120, 16, v68
    v_and_b32 v121, 0xffff0000, v68
    v_lshlrev_b32 v122, 16, v69
    buffer_load_dwordx4 v[116:119], v8, s[48:51], s25 offen offset:1280
    v_and_b32 v123, 0xffff0000, v69
    v_lshlrev_b32 v124, 16, v70
    v_and_b32 v125, 0xffff0000, v70
    v_lshlrev_b32 v126, 16, v71
    v_and_b32 v127, 0xffff0000, v71
    v_fmac_f32 v128, s66, v120
    v_fmac_f32 v129, s70, v121
    v_fmac_f32 v130, s74, v122
    v_fmac_f32 v131, s78, v123
    v_fmac_f32 v132, s82, v124
    v_fmac_f32 v133, s86, v125
    v_fmac_f32 v134, s90, v126
    v_fmac_f32 v135, s94, v127
    v_mul_f32 v136, s67, v120
    v_mul_f32 v137, s71, v121
    v_mul_f32 v138, s75, v122
    v_mul_f32 v139, s79, v123
    v_mul_f32 v140, s83, v124
    v_mul_f32 v141, s87, v125
    v_mul_f32 v142, s91, v126
    v_mul_f32 v143, s95, v127
    v_lshlrev_b32 v120, 16, v72
    v_and_b32 v121, 0xffff0000, v72
    v_lshlrev_b32 v122, 16, v73
    v_and_b32 v123, 0xffff0000, v73
    v_lshlrev_b32 v124, 16, v74
    v_and_b32 v125, 0xffff0000, v74
    v_lshlrev_b32 v126, 16, v75
    v_and_b32 v127, 0xffff0000, v75
    v_fmac_f32 v128, s65, v120
    v_fmac_f32 v129, s69, v121
    v_fmac_f32 v130, s73, v122
    v_fmac_f32 v131, s77, v123
    buffer_load_dwordx4 v[56:59], v8, s[52:55], s23 offen offset:0
    v_fmac_f32 v132, s81, v124
    v_fmac_f32 v133, s85, v125
    v_fmac_f32 v134, s89, v126
    v_fmac_f32 v135, s93, v127
    v_fmac_f32 v136, s66, v120
    v_fmac_f32 v137, s70, v121
    v_fmac_f32 v138, s74, v122
    v_fmac_f32 v139, s78, v123
    v_fmac_f32 v140, s82, v124
    v_fmac_f32 v141, s86, v125
    v_fmac_f32 v142, s90, v126
    v_fmac_f32 v143, s94, v127
    v_lshlrev_b32 v120, 16, v76
    v_and_b32 v121, 0xffff0000, v76
    v_lshlrev_b32 v122, 16, v77
    v_and_b32 v123, 0xffff0000, v77
    v_lshlrev_b32 v124, 16, v78
    v_and_b32 v125, 0xffff0000, v78
    v_lshlrev_b32 v126, 16, v79
    v_and_b32 v127, 0xffff0000, v79
    v_fmac_f32 v128, s64, v120
    v_fmac_f32 v129, s68, v121
    v_fmac_f32 v130, s72, v122
    v_fmac_f32 v131, s76, v123
    v_fmac_f32 v132, s80, v124
    v_fmac_f32 v133, s84, v125
    v_fmac_f32 v134, s88, v126
    v_fmac_f32 v135, s92, v127
    v_fmac_f32 v136, s65, v120
    v_fmac_f32 v137, s69, v121
    v_fmac_f32 v138, s73, v122
    v_fmac_f32 v139, s77, v123
    v_fmac_f32 v140, s81, v124
    buffer_load_dwordx4 v[60:63], v8, s[52:55], s23 offen offset:1280
    v_fmac_f32 v141, s85, v125
    v_fmac_f32 v142, s89, v126
    v_fmac_f32 v143, s93, v127
    v_lshlrev_b32 v120, 16, v80
    v_and_b32 v121, 0xffff0000, v80
    v_lshlrev_b32 v122, 16, v81
    v_and_b32 v123, 0xffff0000, v81
    v_lshlrev_b32 v124, 16, v82
    v_and_b32 v125, 0xffff0000, v82
    v_lshlrev_b32 v126, 16, v83
    v_and_b32 v127, 0xffff0000, v83
    v_fmac_f32 v136, s64, v120
    v_fmac_f32 v137, s68, v121
    v_fmac_f32 v138, s72, v122
    v_fmac_f32 v139, s76, v123
    v_fmac_f32 v140, s80, v124
    v_fmac_f32 v141, s84, v125
    v_fmac_f32 v142, s88, v126
    v_fmac_f32 v143, s92, v127
    v_lshlrev_b32 v120, 16, v84
    v_and_b32 v121, 0xffff0000, v84
    v_lshlrev_b32 v122, 16, v85
    v_and_b32 v123, 0xffff0000, v85
    v_lshlrev_b32 v124, 16, v86
    v_and_b32 v125, 0xffff0000, v86
    v_lshlrev_b32 v126, 16, v87
    v_and_b32 v127, 0xffff0000, v87
    v_mul_f32 v128, v128, v120
    v_mul_f32 v129, v129, v121
    v_mul_f32 v130, v130, v122
    v_mul_f32 v131, v131, v123
    v_mul_f32 v132, v132, v124
    v_mul_f32 v133, v133, v125
    v_mul_f32 v134, v134, v126
    v_mul_f32 v135, v135, v127
    v_lshlrev_b32 v120, 16, v88
    v_and_b32 v121, 0xffff0000, v88
    v_lshlrev_b32 v122, 16, v89
    v_and_b32 v123, 0xffff0000, v89
    v_lshlrev_b32 v124, 16, v90
    v_and_b32 v125, 0xffff0000, v90
    v_lshlrev_b32 v126, 16, v91
    v_and_b32 v127, 0xffff0000, v91
    v_mul_f32 v136, v136, v120
    v_mul_f32 v137, v137, v121
    v_mul_f32 v138, v138, v122
    v_mul_f32 v139, v139, v123
    v_mul_f32 v140, v140, v124
    v_mul_f32 v141, v141, v125
    v_mul_f32 v142, v142, v126
    v_mul_f32 v143, v143, v127
    v_cvt_pk_bf16_f32 v32, v136, v128
    v_cvt_pk_bf16_f32 v33, v137, v129
    v_cvt_pk_bf16_f32 v34, v138, v130
    v_cvt_pk_bf16_f32 v35, v139, v131
    v_cvt_pk_bf16_f32 v36, v140, v132
    v_cvt_pk_bf16_f32 v37, v141, v133
    v_cvt_pk_bf16_f32 v38, v142, v134
    v_cvt_pk_bf16_f32 v39, v143, v135
    ds_write_b32 v10, v32 offset:0
    ds_write_b32 v10, v33 offset:3584
    ds_write_b32 v10, v34 offset:7168
    ds_write_b32 v10, v35 offset:10752
    ds_write_b32 v10, v36 offset:14336
    ds_write_b32 v10, v37 offset:17920
    ds_write_b32 v10, v38 offset:21504
    ds_write_b32 v10, v39 offset:25088
    s_waitcnt lgkmcnt(0)
    s_barrier
    buffer_load_dwordx4 v[48:51], v8, s[52:55], s24 offen offset:0
    s_waitcnt vmcnt(3)
    v_mov_b32_dpp v100, v108 wave_shr:1 row_mask:0xf bank_mask:0xf
    v_mov_b32_dpp v101, v109 wave_shr:1 row_mask:0xf bank_mask:0xf
    v_mov_b32_dpp v102, v110 wave_shr:1 row_mask:0xf bank_mask:0xf
    v_mov_b32_dpp v103, v111 wave_shr:1 row_mask:0xf bank_mask:0xf
    v_mov_b32_dpp v96, v104 wave_shr:1 row_mask:0xf bank_mask:0xf
    v_mov_b32_dpp v97, v105 wave_shr:1 row_mask:0xf bank_mask:0xf
    v_mov_b32_dpp v98, v106 wave_shr:1 row_mask:0xf bank_mask:0xf
    v_mov_b32_dpp v99, v107 wave_shr:1 row_mask:0xf bank_mask:0xf
    v_mov_b32_dpp v92, v100 wave_shr:1 row_mask:0xf bank_mask:0xf
    v_mov_b32_dpp v93, v101 wave_shr:1 row_mask:0xf bank_mask:0xf
    v_mov_b32_dpp v94, v102 wave_shr:1 row_mask:0xf bank_mask:0xf
    v_mov_b32_dpp v95, v103 wave_shr:1 row_mask:0xf bank_mask:0xf
    v_lshlrev_b32 v120, 16, v92
    v_and_b32 v121, 0xffff0000, v92
    v_lshlrev_b32 v122, 16, v93
    v_and_b32 v123, 0xffff0000, v93
    v_lshlrev_b32 v124, 16, v94
    v_and_b32 v125, 0xffff0000, v94
    v_lshlrev_b32 v126, 16, v95
    v_and_b32 v127, 0xffff0000, v95
    v_mul_f32 v128, s67, v120
    v_mul_f32 v129, s71, v121
    v_mul_f32 v130, s75, v122
    v_mul_f32 v131, s79, v123
    v_mul_f32 v132, s83, v124
    v_mul_f32 v133, s87, v125
    v_mul_f32 v134, s91, v126
    v_mul_f32 v135, s95, v127
    v_lshlrev_b32 v120, 16, v96
    v_and_b32 v121, 0xffff0000, v96
    v_lshlrev_b32 v122, 16, v97
    v_and_b32 v123, 0xffff0000, v97
    v_lshlrev_b32 v124, 16, v98
    v_and_b32 v125, 0xffff0000, v98
    v_lshlrev_b32 v126, 16, v99
    v_and_b32 v127, 0xffff0000, v99
    v_fmac_f32 v128, s66, v120
    v_fmac_f32 v129, s70, v121
    v_fmac_f32 v130, s74, v122
    v_fmac_f32 v131, s78, v123
    v_fmac_f32 v132, s82, v124
    v_fmac_f32 v133, s86, v125
    v_fmac_f32 v134, s90, v126
    v_fmac_f32 v135, s94, v127
    v_mul_f32 v136, s67, v120
    v_mul_f32 v137, s71, v121
    v_mul_f32 v138, s75, v122
    v_mul_f32 v139, s79, v123
    v_mul_f32 v140, s83, v124
    v_mul_f32 v141, s87, v125
    v_mul_f32 v142, s91, v126
    v_mul_f32 v143, s95, v127
    v_lshlrev_b32 v120, 16, v100
    v_and_b32 v121, 0xffff0000, v100
    v_lshlrev_b32 v122, 16, v101
    v_and_b32 v123, 0xffff0000, v101
    v_lshlrev_b32 v124, 16, v102
    v_and_b32 v125, 0xffff0000, v102
    v_lshlrev_b32 v126, 16, v103
    v_and_b32 v127, 0xffff0000, v103
    v_fmac_f32 v128, s65, v120
    v_fmac_f32 v129, s69, v121
    v_fmac_f32 v130, s73, v122
    v_fmac_f32 v131, s77, v123
    v_fmac_f32 v132, s81, v124
    v_fmac_f32 v133, s85, v125
    v_fmac_f32 v134, s89, v126
    v_fmac_f32 v135, s93, v127
    v_fmac_f32 v136, s66, v120
    v_fmac_f32 v137, s70, v121
    v_fmac_f32 v138, s74, v122
    v_fmac_f32 v139, s78, v123
    v_fmac_f32 v140, s82, v124
    v_fmac_f32 v141, s86, v125
    v_fmac_f32 v142, s90, v126
    v_fmac_f32 v143, s94, v127
    v_lshlrev_b32 v120, 16, v104
    v_and_b32 v121, 0xffff0000, v104
    v_lshlrev_b32 v122, 16, v105
    v_and_b32 v123, 0xffff0000, v105
    v_lshlrev_b32 v124, 16, v106
    v_and_b32 v125, 0xffff0000, v106
    v_lshlrev_b32 v126, 16, v107
    v_and_b32 v127, 0xffff0000, v107
    v_fmac_f32 v128, s64, v120
    v_fmac_f32 v129, s68, v121
    v_fmac_f32 v130, s72, v122
    v_fmac_f32 v131, s76, v123
    v_fmac_f32 v132, s80, v124
    v_fmac_f32 v133, s84, v125
    buffer_load_dwordx4 v[52:55], v8, s[52:55], s24 offen offset:1280
    v_fmac_f32 v134, s88, v126
    v_fmac_f32 v135, s92, v127
    v_fmac_f32 v136, s65, v120
    v_fmac_f32 v137, s69, v121
    v_fmac_f32 v138, s73, v122
    v_fmac_f32 v139, s77, v123
    v_fmac_f32 v140, s81, v124
    v_fmac_f32 v141, s85, v125
    v_fmac_f32 v142, s89, v126
    v_fmac_f32 v143, s93, v127
    v_lshlrev_b32 v120, 16, v108
    v_and_b32 v121, 0xffff0000, v108
    v_lshlrev_b32 v122, 16, v109
    v_and_b32 v123, 0xffff0000, v109
    v_lshlrev_b32 v124, 16, v110
    v_and_b32 v125, 0xffff0000, v110
    v_lshlrev_b32 v126, 16, v111
    v_and_b32 v127, 0xffff0000, v111
    v_fmac_f32 v136, s64, v120
    v_fmac_f32 v137, s68, v121
    v_fmac_f32 v138, s72, v122
    v_fmac_f32 v139, s76, v123
    v_fmac_f32 v140, s80, v124
    v_fmac_f32 v141, s84, v125
    v_fmac_f32 v142, s88, v126
    v_fmac_f32 v143, s92, v127
    v_lshlrev_b32 v120, 16, v112
    v_and_b32 v121, 0xffff0000, v112
    v_lshlrev_b32 v122, 16, v113
    v_and_b32 v123, 0xffff0000, v113
    v_lshlrev_b32 v124, 16, v114
    v_and_b32 v125, 0xffff0000, v114
    v_lshlrev_b32 v126, 16, v115
    v_and_b32 v127, 0xffff0000, v115
    v_mul_f32 v128, v128, v120
    v_mul_f32 v129, v129, v121
    v_mul_f32 v130, v130, v122
    v_mul_f32 v131, v131, v123
    v_mul_f32 v132, v132, v124
    v_mul_f32 v133, v133, v125
    v_mul_f32 v134, v134, v126
    v_mul_f32 v135, v135, v127
    v_lshlrev_b32 v120, 16, v116
    v_and_b32 v121, 0xffff0000, v116
    v_lshlrev_b32 v122, 16, v117
    v_and_b32 v123, 0xffff0000, v117
    v_lshlrev_b32 v124, 16, v118
    v_and_b32 v125, 0xffff0000, v118
    v_lshlrev_b32 v126, 16, v119
    v_and_b32 v127, 0xffff0000, v119
    v_mul_f32 v136, v136, v120
    v_mul_f32 v137, v137, v121
    v_mul_f32 v138, v138, v122
    v_mul_f32 v139, v139, v123
    v_mul_f32 v140, v140, v124
    v_mul_f32 v141, v141, v125
    v_mul_f32 v142, v142, v126
    v_mul_f32 v143, v143, v127
    v_cvt_pk_bf16_f32 v40, v136, v128
    v_cvt_pk_bf16_f32 v41, v137, v129
    v_cvt_pk_bf16_f32 v42, v138, v130
    v_cvt_pk_bf16_f32 v43, v139, v131
    v_cvt_pk_bf16_f32 v44, v140, v132
    v_cvt_pk_bf16_f32 v45, v141, v133
    v_cvt_pk_bf16_f32 v46, v142, v134
    v_cvt_pk_bf16_f32 v47, v143, v135
    ds_write_b32 v10, v40 offset:2048
    ds_write_b32 v10, v41 offset:5632
    ds_write_b32 v10, v42 offset:9216
    ds_write_b32 v10, v43 offset:12800
    ds_write_b32 v10, v44 offset:16384
    ds_write_b32 v10, v45 offset:19968
    ds_write_b32 v10, v46 offset:23552
    ds_write_b32 v10, v47 offset:27136
    ds_write_b32 v11, v32 offset:0
    ds_write_b32 v11, v33 offset:3584
    ds_write_b32 v11, v34 offset:7168
    ds_write_b32 v11, v35 offset:10752
    ds_write_b32 v11, v36 offset:14336
    ds_write_b32 v11, v37 offset:17920
    ds_write_b32 v11, v38 offset:21504
    ds_write_b32 v11, v39 offset:25088
    ds_read_b32 v144, v12 offset:4160
    ds_read_b32 v145, v12 offset:21056
    ds_read_b32 v146, v12 offset:37952
    ds_read_b32 v147, v12 offset:54848
    ds_read_b32 v148, v13 offset:4160
    ds_read_b32 v149, v13 offset:21056
    ds_read_b32 v150, v13 offset:37952
    ds_read_b32 v151, v13 offset:54848
    v_and_b32 v120, 0xffff0000, v24
    v_and_b32 v121, 0xffff0000, v25
    v_and_b32 v122, 0xffff0000, v26
    v_and_b32 v123, 0xffff0000, v27
    v_and_b32 v124, 0xffff0000, v28
    v_and_b32 v125, 0xffff0000, v29
    v_and_b32 v126, 0xffff0000, v30
    v_and_b32 v127, 0xffff0000, v31
    s_waitcnt lgkmcnt(0)
    v_lshlrev_b32 v128, 16, v144
    v_lshlrev_b32 v129, 16, v145
    v_lshlrev_b32 v130, 16, v146
    v_lshlrev_b32 v131, 16, v147
    v_lshlrev_b32 v132, 16, v148
    v_lshlrev_b32 v133, 16, v149
    v_lshlrev_b32 v134, 16, v150
    v_lshlrev_b32 v135, 16, v151
    v_fmac_f32 v128, s4, v120
    v_fmac_f32 v129, s5, v121
    v_fmac_f32 v130, s6, v122
    v_fmac_f32 v131, s7, v123
    v_fmac_f32 v132, s8, v124
    v_fmac_f32 v133, s9, v125
    v_fmac_f32 v134, s10, v126
    v_fmac_f32 v135, s11, v127
    s_waitcnt vmcnt(2)
    v_lshlrev_b32 v120, 16, v56
    v_and_b32 v121, 0xffff0000, v56
    v_lshlrev_b32 v122, 16, v57
    v_and_b32 v123, 0xffff0000, v57
    v_lshlrev_b32 v124, 16, v58
    v_and_b32 v125, 0xffff0000, v58
    v_lshlrev_b32 v126, 16, v59
    v_and_b32 v127, 0xffff0000, v59
    v_mul_f32 v128, v128, v120
    v_mul_f32 v129, v129, v121
    v_mul_f32 v130, v130, v122
    v_mul_f32 v131, v131, v123
    v_mul_f32 v132, v132, v124
    v_mul_f32 v133, v133, v125
    v_mul_f32 v134, v134, v126
    v_mul_f32 v135, v135, v127
    v_cvt_pk_bf16_f32 v160, v128, v129
    v_cvt_pk_bf16_f32 v161, v130, v131
    v_cvt_pk_bf16_f32 v162, v132, v133
    v_cvt_pk_bf16_f32 v163, v134, v135
    buffer_store_dwordx4 v[160:163], v9, s[60:63], s32 offen offset:0
    v_lshlrev_b32 v120, 16, v24
    v_lshlrev_b32 v121, 16, v25
    v_lshlrev_b32 v122, 16, v26
    v_lshlrev_b32 v123, 16, v27
    v_lshlrev_b32 v124, 16, v28
    v_lshlrev_b32 v125, 16, v29
    v_lshlrev_b32 v126, 16, v30
    v_lshlrev_b32 v127, 16, v31
    v_and_b32 v128, 0xffff0000, v144
    v_and_b32 v129, 0xffff0000, v145
    v_and_b32 v130, 0xffff0000, v146
    v_and_b32 v131, 0xffff0000, v147
    v_and_b32 v132, 0xffff0000, v148
    v_and_b32 v133, 0xffff0000, v149
    v_and_b32 v134, 0xffff0000, v150
    v_and_b32 v135, 0xffff0000, v151
    v_fmac_f32 v128, s4, v120
    v_fmac_f32 v129, s5, v121
    v_fmac_f32 v130, s6, v122
    v_fmac_f32 v131, s7, v123
    v_fmac_f32 v132, s8, v124
    v_fmac_f32 v133, s9, v125
    v_fmac_f32 v134, s10, v126
    v_fmac_f32 v135, s11, v127
    v_lshlrev_b32 v120, 16, v60
    v_and_b32 v121, 0xffff0000, v60
    v_lshlrev_b32 v122, 16, v61
    v_and_b32 v123, 0xffff0000, v61
    v_lshlrev_b32 v124, 16, v62
    v_and_b32 v125, 0xffff0000, v62
    v_lshlrev_b32 v126, 16, v63
    v_and_b32 v127, 0xffff0000, v63
    v_mul_f32 v128, v128, v120
    v_mul_f32 v129, v129, v121
    v_mul_f32 v130, v130, v122
    v_mul_f32 v131, v131, v123
    v_mul_f32 v132, v132, v124
    v_mul_f32 v133, v133, v125
    v_mul_f32 v134, v134, v126
    v_mul_f32 v135, v135, v127
    v_cvt_pk_bf16_f32 v164, v128, v129
    v_cvt_pk_bf16_f32 v165, v130, v131
    v_cvt_pk_bf16_f32 v166, v132, v133
    v_cvt_pk_bf16_f32 v167, v134, v135
    buffer_store_dwordx4 v[164:167], v9, s[60:63], s32 offen offset:2560
    s_waitcnt lgkmcnt(0)
    s_barrier
    buffer_load_dwordx4 v[56:59], v8, s[52:55], s25 offen offset:0
    buffer_load_dwordx4 v[60:63], v8, s[52:55], s25 offen offset:1280
    ds_read_b32 v144, v12 offset:8320
    ds_read_b32 v145, v12 offset:25216
    ds_read_b32 v146, v12 offset:42112
    ds_read_b32 v147, v12 offset:59008
    ds_read_b32 v148, v13 offset:8320
    ds_read_b32 v149, v13 offset:25216
    ds_read_b32 v150, v13 offset:42112
    ds_read_b32 v151, v13 offset:59008
    v_and_b32 v120, 0xffff0000, v32
    v_and_b32 v121, 0xffff0000, v33
    v_and_b32 v122, 0xffff0000, v34
    v_and_b32 v123, 0xffff0000, v35
    v_and_b32 v124, 0xffff0000, v36
    v_and_b32 v125, 0xffff0000, v37
    v_and_b32 v126, 0xffff0000, v38
    v_and_b32 v127, 0xffff0000, v39
    s_waitcnt lgkmcnt(0)
    v_lshlrev_b32 v128, 16, v144
    v_lshlrev_b32 v129, 16, v145
    v_lshlrev_b32 v130, 16, v146
    v_lshlrev_b32 v131, 16, v147
    v_lshlrev_b32 v132, 16, v148
    v_lshlrev_b32 v133, 16, v149
    v_lshlrev_b32 v134, 16, v150
    v_lshlrev_b32 v135, 16, v151
    v_fmac_f32 v128, s4, v120
    v_fmac_f32 v129, s5, v121
    v_fmac_f32 v130, s6, v122
    v_fmac_f32 v131, s7, v123
    v_fmac_f32 v132, s8, v124
    v_fmac_f32 v133, s9, v125
    v_fmac_f32 v134, s10, v126
    v_fmac_f32 v135, s11, v127
    s_waitcnt vmcnt(4)
    v_lshlrev_b32 v120, 16, v48
    v_and_b32 v121, 0xffff0000, v48
    v_lshlrev_b32 v122, 16, v49
    v_and_b32 v123, 0xffff0000, v49
    v_lshlrev_b32 v124, 16, v50
    v_and_b32 v125, 0xffff0000, v50
    v_lshlrev_b32 v126, 16, v51
    v_and_b32 v127, 0xffff0000, v51
    v_mul_f32 v128, v128, v120
    v_mul_f32 v129, v129, v121
    v_mul_f32 v130, v130, v122
    v_mul_f32 v131, v131, v123
    v_mul_f32 v132, v132, v124
    v_mul_f32 v133, v133, v125
    v_mul_f32 v134, v134, v126
    v_mul_f32 v135, v135, v127
    v_cvt_pk_bf16_f32 v152, v128, v129
    v_cvt_pk_bf16_f32 v153, v130, v131
    v_cvt_pk_bf16_f32 v154, v132, v133
    v_cvt_pk_bf16_f32 v155, v134, v135
    buffer_store_dwordx4 v[152:155], v9, s[60:63], s33 offen offset:0
    v_lshlrev_b32 v120, 16, v32
    v_lshlrev_b32 v121, 16, v33
    v_lshlrev_b32 v122, 16, v34
    v_lshlrev_b32 v123, 16, v35
    v_lshlrev_b32 v124, 16, v36
    v_lshlrev_b32 v125, 16, v37
    v_lshlrev_b32 v126, 16, v38
    v_lshlrev_b32 v127, 16, v39
    v_and_b32 v128, 0xffff0000, v144
    v_and_b32 v129, 0xffff0000, v145
    v_and_b32 v130, 0xffff0000, v146
    v_and_b32 v131, 0xffff0000, v147
    v_and_b32 v132, 0xffff0000, v148
    v_and_b32 v133, 0xffff0000, v149
    v_and_b32 v134, 0xffff0000, v150
    v_and_b32 v135, 0xffff0000, v151
    v_fmac_f32 v128, s4, v120
    v_fmac_f32 v129, s5, v121
    v_fmac_f32 v130, s6, v122
    v_fmac_f32 v131, s7, v123
    v_fmac_f32 v132, s8, v124
    v_fmac_f32 v133, s9, v125
    v_fmac_f32 v134, s10, v126
    v_fmac_f32 v135, s11, v127
    v_lshlrev_b32 v120, 16, v52
    v_and_b32 v121, 0xffff0000, v52
    v_lshlrev_b32 v122, 16, v53
    v_and_b32 v123, 0xffff0000, v53
    v_lshlrev_b32 v124, 16, v54
    v_and_b32 v125, 0xffff0000, v54
    v_lshlrev_b32 v126, 16, v55
    v_and_b32 v127, 0xffff0000, v55
    v_mul_f32 v128, v128, v120
    v_mul_f32 v129, v129, v121
    v_mul_f32 v130, v130, v122
    v_mul_f32 v131, v131, v123
    v_mul_f32 v132, v132, v124
    v_mul_f32 v133, v133, v125
    v_mul_f32 v134, v134, v126
    v_mul_f32 v135, v135, v127
    v_cvt_pk_bf16_f32 v156, v128, v129
    v_cvt_pk_bf16_f32 v157, v130, v131
    v_cvt_pk_bf16_f32 v158, v132, v133
    v_cvt_pk_bf16_f32 v159, v134, v135
    buffer_store_dwordx4 v[156:159], v9, s[60:63], s33 offen offset:2560
    s_waitcnt lgkmcnt(0)
    s_barrier
    ds_read_b32 v144, v12 offset:12480
    ds_read_b32 v145, v12 offset:29376
    ds_read_b32 v146, v12 offset:46272
    ds_read_b32 v147, v12 offset:63168
    ds_read_b32 v148, v13 offset:12480
    ds_read_b32 v149, v13 offset:29376
    ds_read_b32 v150, v13 offset:46272
    ds_read_b32 v151, v13 offset:63168
    v_and_b32 v120, 0xffff0000, v40
    v_and_b32 v121, 0xffff0000, v41
    v_and_b32 v122, 0xffff0000, v42
    v_and_b32 v123, 0xffff0000, v43
    v_and_b32 v124, 0xffff0000, v44
    v_and_b32 v125, 0xffff0000, v45
    v_and_b32 v126, 0xffff0000, v46
    v_and_b32 v127, 0xffff0000, v47
    s_waitcnt lgkmcnt(0)
    v_lshlrev_b32 v128, 16, v144
    v_lshlrev_b32 v129, 16, v145
    v_lshlrev_b32 v130, 16, v146
    v_lshlrev_b32 v131, 16, v147
    v_lshlrev_b32 v132, 16, v148
    v_lshlrev_b32 v133, 16, v149
    v_lshlrev_b32 v134, 16, v150
    v_lshlrev_b32 v135, 16, v151
    v_fmac_f32 v128, s4, v120
    v_fmac_f32 v129, s5, v121
    v_fmac_f32 v130, s6, v122
    v_fmac_f32 v131, s7, v123
    v_fmac_f32 v132, s8, v124
    v_fmac_f32 v133, s9, v125
    v_fmac_f32 v134, s10, v126
    v_fmac_f32 v135, s11, v127
    s_waitcnt vmcnt(2)
    v_lshlrev_b32 v120, 16, v56
    v_and_b32 v121, 0xffff0000, v56
    v_lshlrev_b32 v122, 16, v57
    v_and_b32 v123, 0xffff0000, v57
    v_lshlrev_b32 v124, 16, v58
    v_and_b32 v125, 0xffff0000, v58
    v_lshlrev_b32 v126, 16, v59
    v_and_b32 v127, 0xffff0000, v59
    v_mul_f32 v128, v128, v120
    v_mul_f32 v129, v129, v121
    v_mul_f32 v130, v130, v122
    v_mul_f32 v131, v131, v123
    v_mul_f32 v132, v132, v124
    v_mul_f32 v133, v133, v125
    v_mul_f32 v134, v134, v126
    v_mul_f32 v135, v135, v127
    v_cvt_pk_bf16_f32 v160, v128, v129
    v_cvt_pk_bf16_f32 v161, v130, v131
    v_cvt_pk_bf16_f32 v162, v132, v133
    v_cvt_pk_bf16_f32 v163, v134, v135
    buffer_store_dwordx4 v[160:163], v9, s[60:63], s34 offen offset:0
    v_lshlrev_b32 v120, 16, v40
    v_lshlrev_b32 v121, 16, v41
    v_lshlrev_b32 v122, 16, v42
    v_lshlrev_b32 v123, 16, v43
    v_lshlrev_b32 v124, 16, v44
    v_lshlrev_b32 v125, 16, v45
    v_lshlrev_b32 v126, 16, v46
    v_lshlrev_b32 v127, 16, v47
    v_and_b32 v128, 0xffff0000, v144
    v_and_b32 v129, 0xffff0000, v145
    v_and_b32 v130, 0xffff0000, v146
    v_and_b32 v131, 0xffff0000, v147
    v_and_b32 v132, 0xffff0000, v148
    v_and_b32 v133, 0xffff0000, v149
    v_and_b32 v134, 0xffff0000, v150
    v_and_b32 v135, 0xffff0000, v151
    v_fmac_f32 v128, s4, v120
    v_fmac_f32 v129, s5, v121
    v_fmac_f32 v130, s6, v122
    v_fmac_f32 v131, s7, v123
    v_fmac_f32 v132, s8, v124
    v_fmac_f32 v133, s9, v125
    v_fmac_f32 v134, s10, v126
    v_fmac_f32 v135, s11, v127
    v_lshlrev_b32 v120, 16, v60
    v_and_b32 v121, 0xffff0000, v60
    v_lshlrev_b32 v122, 16, v61
    v_and_b32 v123, 0xffff0000, v61
    v_lshlrev_b32 v124, 16, v62
    v_and_b32 v125, 0xffff0000, v62
    v_lshlrev_b32 v126, 16, v63
    v_and_b32 v127, 0xffff0000, v63
    v_mul_f32 v128, v128, v120
    v_mul_f32 v129, v129, v121
    v_mul_f32 v130, v130, v122
    v_mul_f32 v131, v131, v123
    v_mul_f32 v132, v132, v124
    v_mul_f32 v133, v133, v125
    v_mul_f32 v134, v134, v126
    v_mul_f32 v135, v135, v127
    v_cvt_pk_bf16_f32 v164, v128, v129
    v_cvt_pk_bf16_f32 v165, v130, v131
    v_cvt_pk_bf16_f32 v166, v132, v133
    v_cvt_pk_bf16_f32 v167, v134, v135
    buffer_store_dwordx4 v[164:167], v9, s[60:63], s34 offen offset:2560
    s_endpgm
L_helper:
    s_sub_u32 s40, s40, 4
    v_subrev_u32 v0, 256, v0
    s_waitcnt lgkmcnt(0)
    s_mov_b32 s44, s6
    s_and_b32 s45, s7, 0xffff
    s_mov_b32 s46, 0x280000
    s_mov_b32 s47, 0x00020000
    s_mov_b32 s48, s8
    s_and_b32 s49, s9, 0xffff
    s_mov_b32 s50, 0x280000
    s_mov_b32 s51, 0x00020000
    s_mov_b32 s52, s4
    s_and_b32 s53, s5, 0xffff
    s_mov_b32 s54, 0x280000
    s_mov_b32 s55, 0x00020000
    s_mov_b32 s56, s12
    s_and_b32 s57, s13, 0xffff
    s_mov_b32 s58, 0x280000
    s_mov_b32 s59, 0x00020000
    s_lshr_b32 s64, s97, 3
    s_lshl_b32 s100, s64, 7
    v_mul_u32_u24 v32, 1280, v0
    v_add_u32 v32, s100, v32
    s_cmp_eq_u32 s3, 2
    s_cbranch_scc1 L_h0
    s_barrier
L_h0:
    s_bitcmp1_b32 s97, 0
    s_cbranch_scc0 L_h2
    s_cmp_ge_u32 s40, 2
    s_cbranch_scc1 L_h1t
    s_mul_i32 s99, s42, 81920
    s_mul_i32 s101, s40, 573440
    s_add_u32 s99, s99, s101
    buffer_load_dword v33, v32, s[48:51], s99 offen
    s_branch L_h1e
L_h1t:
    v_and_b32 v34, 15, v0
    v_bfe_u32 v35, v0, 4, 3
    v_lshlrev_b32 v34, 7, v34
    v_lshl_add_u32 v34, v35, 12, v34
    s_lshl_b32 s99, s64, 3
    s_add_u32 s99, s99, s42
    s_lshl_b32 s99, s99, 15
    buffer_load_dword v33, v34, s[56:59], s99 offen offset:2048
L_h1e:
    s_waitcnt vmcnt(0)
L_h2:
    s_cmp_lg_u32 s3, 2
    s_cbranch_scc1 L_h2a
    s_barrier
    s_branch L_h2b
L_h2a:
    s_mov_b32 s60, s16
    s_and_b32 s61, s17, 0xffff
    s_mov_b32 s62, 0x280000
    s_mov_b32 s63, 0x00020000
    s_lshl_b32 s99, s43, 1
    v_mul_u32_u24 v34, 1280, v0
    v_add_u32 v34, s99, v34
    s_mul_i32 s99, s42, 327680
    buffer_load_dword v33, v34, s[60:63], s99 offen
    s_waitcnt vmcnt(0)
L_h2b:
    s_bitcmp1_b32 s97, 1
    s_cbranch_scc0 L_h3
    s_lshr_b32 s99, s42, 1
    s_add_u32 s99, s99, 4
    s_mul_i32 s99, s99, 327680
    s_bitcmp1_b32 s42, 0
    s_cbranch_scc1 L_h2v
    buffer_load_dword v33, v32, s[44:47], s99 offen
    s_branch L_h2e
L_h2v:
    buffer_load_dword v33, v32, s[48:51], s99 offen
L_h2e:
    s_bitcmp1_b32 s97, 2
    s_cbranch_scc0 L_h4
    s_waitcnt vmcnt(0)
L_h3:
    s_bitcmp1_b32 s97, 2
    s_cbranch_scc0 L_h4
    s_mul_i32 s99, s42, 327680
    buffer_load_dword v33, v32, s[52:55], s99 offen
L_h4:
    s_cmp_eq_u32 s3, 2
    s_cbranch_scc1 L_end
    s_mov_b32 s44, s16
    s_and_b32 s45, s17, 0xffff
    s_mov_b32 s46, 0x280000
    s_mov_b32 s47, 0x00020000
    s_mov_b32 s60, s34
    s_and_b32 s61, s35, 0xffff
    s_mov_b32 s62, 0x500000
    s_mov_b32 s63, 0x00020000
    s_lshl_b32 s99, s43, 1
    s_add_u32 s100, s32, s99
    s_addc_u32 s101, s33, 0
    s_load_dwordx2 s[92:93], s[100:101], 0
    s_lshl_b32 s99, s43, 1
    v_mul_u32_u24 v34, 2560, v0
    v_add_u32 v8, s99, v34
    s_add_u32 s99, s99, 1280
    v_lshl_add_u32 v9, v34, 1, s99
    v_lshlrev_b32 v34, 2, v0
    v_sub_u32 v10, 136188, v34
    v_add_u32 v12, 3136, v34
    v_add_u32 v13, 70720, v34
    v_and_b32 v34, 28, v34
    v_add_u32 v34, 138720, v34
    v_add_u32 v11, 3072, v10
    v_cmp_gt_u32 vcc, 128, v0
    s_waitcnt lgkmcnt(0)
    s_lshl_b32 s4, s92, 16
    s_and_b32 s5, s92, 0xffff0000
    s_lshl_b32 s6, s93, 16
    s_and_b32 s7, s93, 0xffff0000
    v_cndmask_b32 v11, v11, v34, vcc
    s_mov_b32 s26, 0x05040100
    s_mov_b32 s27, 0x07060302
    s_mov_b32 s23, 655360
    s_mov_b32 s32, 1310720
    s_mov_b32 s24, 1310720
    s_mov_b32 s33, 2621440
    s_mov_b32 s25, 1966080
    s_mov_b32 s34, 3932160
    buffer_load_dwordx2 v[48:49], v8, s[44:47], 0 offen offset:0
    buffer_load_dwordx2 v[50:51], v8, s[44:47], 0 offen offset:1280
    buffer_load_dwordx2 v[52:53], v8, s[44:47], s23 offen offset:0
    buffer_load_dwordx2 v[54:55], v8, s[44:47], s23 offen offset:1280
    s_waitcnt vmcnt(2)
    v_perm_b32 v16, v48, v50, s26
    v_perm_b32 v17, v48, v50, s27
    v_perm_b32 v18, v49, v51, s26
    v_perm_b32 v19, v49, v51, s27
    ds_write_b32 v10, v16 offset:2048
    ds_write_b32 v10, v17 offset:5632
    ds_write_b32 v10, v18 offset:9216
    ds_write_b32 v10, v19 offset:12800
    s_waitcnt lgkmcnt(0)
    s_barrier
    buffer_load_dwordx2 v[56:57], v8, s[44:47], s24 offen offset:0
    buffer_load_dwordx2 v[58:59], v8, s[44:47], s24 offen offset:1280
    buffer_load_dwordx2 v[60:61], v8, s[44:47], s25 offen offset:0
    buffer_load_dwordx2 v[62:63], v8, s[44:47], s25 offen offset:1280
    s_waitcnt vmcnt(4)
    v_perm_b32 v20, v52, v54, s26
    v_perm_b32 v21, v52, v54, s27
    v_perm_b32 v22, v53, v55, s26
    v_perm_b32 v23, v53, v55, s27
    ds_write_b32 v10, v20 offset:1024
    ds_write_b32 v10, v21 offset:4608
    ds_write_b32 v10, v22 offset:8192
    ds_write_b32 v10, v23 offset:11776
    s_waitcnt lgkmcnt(0)
    s_barrier
    s_waitcnt vmcnt(2)
    v_perm_b32 v24, v56, v58, s26
    v_perm_b32 v25, v56, v58, s27
    v_perm_b32 v26, v57, v59, s26
    v_perm_b32 v27, v57, v59, s27
    ds_write_b32 v10, v24 offset:0
    ds_write_b32 v10, v25 offset:3584
    ds_write_b32 v10, v26 offset:7168
    ds_write_b32 v10, v27 offset:10752
    ds_read_b32 v144, v12 offset:0
    ds_read_b32 v145, v12 offset:16896
    ds_read_b32 v146, v12 offset:33792
    ds_read_b32 v147, v12 offset:50688
    v_and_b32 v120, 0xffff0000, v16
    v_and_b32 v121, 0xffff0000, v17
    v_and_b32 v122, 0xffff0000, v18
    v_and_b32 v123, 0xffff0000, v19
    s_waitcnt lgkmcnt(0)
    v_lshlrev_b32 v128, 16, v144
    v_lshlrev_b32 v129, 16, v145
    v_lshlrev_b32 v130, 16, v146
    v_lshlrev_b32 v131, 16, v147
    v_fmac_f32 v128, s4, v120
    v_fmac_f32 v129, s5, v121
    v_fmac_f32 v130, s6, v122
    v_fmac_f32 v131, s7, v123
    v_cvt_pk_bf16_f32 v152, v128, v129
    v_cvt_pk_bf16_f32 v153, v130, v131
    buffer_store_dwordx2 v[152:153], v9, s[60:63], 0 offen offset:0
    v_lshlrev_b32 v120, 16, v16
    v_lshlrev_b32 v121, 16, v17
    v_lshlrev_b32 v122, 16, v18
    v_lshlrev_b32 v123, 16, v19
    v_and_b32 v128, 0xffff0000, v144
    v_and_b32 v129, 0xffff0000, v145
    v_and_b32 v130, 0xffff0000, v146
    v_and_b32 v131, 0xffff0000, v147
    v_fmac_f32 v128, s4, v120
    v_fmac_f32 v129, s5, v121
    v_fmac_f32 v130, s6, v122
    v_fmac_f32 v131, s7, v123
    v_cvt_pk_bf16_f32 v156, v128, v129
    v_cvt_pk_bf16_f32 v157, v130, v131
    buffer_store_dwordx2 v[156:157], v9, s[60:63], 0 offen offset:2560
    s_waitcnt lgkmcnt(0)
    s_barrier
    s_waitcnt vmcnt(2)
    v_perm_b32 v28, v60, v62, s26
    v_perm_b32 v29, v60, v62, s27
    v_perm_b32 v30, v61, v63, s26
    v_perm_b32 v31, v61, v63, s27
    ds_write_b32 v10, v28 offset:2048
    ds_write_b32 v10, v29 offset:5632
    ds_write_b32 v10, v30 offset:9216
    ds_write_b32 v10, v31 offset:12800
    ds_write_b32 v11, v24 offset:0
    ds_write_b32 v11, v25 offset:3584
    ds_write_b32 v11, v26 offset:7168
    ds_write_b32 v11, v27 offset:10752
    ds_read_b32 v144, v12 offset:4160
    ds_read_b32 v145, v12 offset:21056
    ds_read_b32 v146, v12 offset:37952
    ds_read_b32 v147, v12 offset:54848
    v_and_b32 v120, 0xffff0000, v20
    v_and_b32 v121, 0xffff0000, v21
    v_and_b32 v122, 0xffff0000, v22
    v_and_b32 v123, 0xffff0000, v23
    s_waitcnt lgkmcnt(0)
    v_lshlrev_b32 v128, 16, v144
    v_lshlrev_b32 v129, 16, v145
    v_lshlrev_b32 v130, 16, v146
    v_lshlrev_b32 v131, 16, v147
    v_fmac_f32 v128, s4, v120
    v_fmac_f32 v129, s5, v121
    v_fmac_f32 v130, s6, v122
    v_fmac_f32 v131, s7, v123
    v_cvt_pk_bf16_f32 v160, v128, v129
    v_cvt_pk_bf16_f32 v161, v130, v131
    buffer_store_dwordx2 v[160:161], v9, s[60:63], s32 offen offset:0
    v_lshlrev_b32 v120, 16, v20
    v_lshlrev_b32 v121, 16, v21
    v_lshlrev_b32 v122, 16, v22
    v_lshlrev_b32 v123, 16, v23
    v_and_b32 v128, 0xffff0000, v144
    v_and_b32 v129, 0xffff0000, v145
    v_and_b32 v130, 0xffff0000, v146
    v_and_b32 v131, 0xffff0000, v147
    v_fmac_f32 v128, s4, v120
    v_fmac_f32 v129, s5, v121
    v_fmac_f32 v130, s6, v122
    v_fmac_f32 v131, s7, v123
    v_cvt_pk_bf16_f32 v164, v128, v129
    v_cvt_pk_bf16_f32 v165, v130, v131
    buffer_store_dwordx2 v[164:165], v9, s[60:63], s32 offen offset:2560
    s_waitcnt lgkmcnt(0)
    s_barrier
    ds_read_b32 v144, v12 offset:8320
    ds_read_b32 v145, v12 offset:25216
    ds_read_b32 v146, v12 offset:42112
    ds_read_b32 v147, v12 offset:59008
    v_and_b32 v120, 0xffff0000, v24
    v_and_b32 v121, 0xffff0000, v25
    v_and_b32 v122, 0xffff0000, v26
    v_and_b32 v123, 0xffff0000, v27
    s_waitcnt lgkmcnt(0)
    v_lshlrev_b32 v128, 16, v144
    v_lshlrev_b32 v129, 16, v145
    v_lshlrev_b32 v130, 16, v146
    v_lshlrev_b32 v131, 16, v147
    v_fmac_f32 v128, s4, v120
    v_fmac_f32 v129, s5, v121
    v_fmac_f32 v130, s6, v122
    v_fmac_f32 v131, s7, v123
    v_cvt_pk_bf16_f32 v152, v128, v129
    v_cvt_pk_bf16_f32 v153, v130, v131
    buffer_store_dwordx2 v[152:153], v9, s[60:63], s33 offen offset:0
    v_lshlrev_b32 v120, 16, v24
    v_lshlrev_b32 v121, 16, v25
    v_lshlrev_b32 v122, 16, v26
    v_lshlrev_b32 v123, 16, v27
    v_and_b32 v128, 0xffff0000, v144
    v_and_b32 v129, 0xffff0000, v145
    v_and_b32 v130, 0xffff0000, v146
    v_and_b32 v131, 0xffff0000, v147
    v_fmac_f32 v128, s4, v120
    v_fmac_f32 v129, s5, v121
    v_fmac_f32 v130, s6, v122
    v_fmac_f32 v131, s7, v123
    v_cvt_pk_bf16_f32 v156, v128, v129
    v_cvt_pk_bf16_f32 v157, v130, v131
    buffer_store_dwordx2 v[156:157], v9, s[60:63], s33 offen offset:2560
    s_waitcnt lgkmcnt(0)
    s_barrier
    ds_read_b32 v144, v12 offset:12480
    ds_read_b32 v145, v12 offset:29376
    ds_read_b32 v146, v12 offset:46272
    ds_read_b32 v147, v12 offset:63168
    v_and_b32 v120, 0xffff0000, v28
    v_and_b32 v121, 0xffff0000, v29
    v_and_b32 v122, 0xffff0000, v30
    v_and_b32 v123, 0xffff0000, v31
    s_waitcnt lgkmcnt(0)
    v_lshlrev_b32 v128, 16, v144
    v_lshlrev_b32 v129, 16, v145
    v_lshlrev_b32 v130, 16, v146
    v_lshlrev_b32 v131, 16, v147
    v_fmac_f32 v128, s4, v120
    v_fmac_f32 v129, s5, v121
    v_fmac_f32 v130, s6, v122
    v_fmac_f32 v131, s7, v123
    v_cvt_pk_bf16_f32 v160, v128, v129
    v_cvt_pk_bf16_f32 v161, v130, v131
    buffer_store_dwordx2 v[160:161], v9, s[60:63], s34 offen offset:0
    v_lshlrev_b32 v120, 16, v28
    v_lshlrev_b32 v121, 16, v29
    v_lshlrev_b32 v122, 16, v30
    v_lshlrev_b32 v123, 16, v31
    v_and_b32 v128, 0xffff0000, v144
    v_and_b32 v129, 0xffff0000, v145
    v_and_b32 v130, 0xffff0000, v146
    v_and_b32 v131, 0xffff0000, v147
    v_fmac_f32 v128, s4, v120
    v_fmac_f32 v129, s5, v121
    v_fmac_f32 v130, s6, v122
    v_fmac_f32 v131, s7, v123
    v_cvt_pk_bf16_f32 v164, v128, v129
    v_cvt_pk_bf16_f32 v165, v130, v131
    buffer_store_dwordx2 v[164:165], v9, s[60:63], s34 offen offset:2560
    s_endpgm
L_end:
    s_endpgm
.section .rodata,"a"
.p2align 6
.amdhsa_kernel concat_heads__ssm_conv_h3__ssm_conv_s4__prompt_kernel
  .amdhsa_next_free_vgpr 168
  .amdhsa_next_free_sgpr 102
  .amdhsa_accum_offset 168
  .amdhsa_group_segment_fixed_size 0
  .amdhsa_kernarg_size 144
  .amdhsa_user_sgpr_count 2
  .amdhsa_user_sgpr_kernarg_segment_ptr 1
  .amdhsa_system_sgpr_workgroup_id_x 1
.end_amdhsa_kernel
```
